```python
import torch

def _softmax(x, axis=-1):
    return torch.softmax(x, dim=axis)
def _gelu(x):
    return torch.nn.functional.gelu(x, approximate="tanh")
def _silu(x):
    return torch.nn.functional.silu(x)
def _sigmoid(x):
    return torch.sigmoid(x)
def _layernorm(x, axis=-1, eps=1e-5):
    m = x.mean(dim=axis, keepdim=True)
    v = x.var(dim=axis, keepdim=True, unbiased=False)
    return (x - m) / torch.sqrt(v + eps)
def _scatter_add(tgt, idx, src, axis=0):
    return tgt.clone().index_add_(axis, idx, src)
def _segment_sum(src, seg, n):
    out = torch.zeros((n,) + src.shape[1:], dtype=src.dtype)
    return out.index_add_(0, seg, src)
def _pad(x, pw):
    flat = tuple(v for pair in reversed(pw) for v in pair)
    return torch.nn.functional.pad(x, flat)

kernel_name = 'sequential_preLN__sliding_block_cached__glu_gated_bilinear__decode'

def setup_inputs():

    _w = (lambda a: (lambda t: t.to(torch.bfloat16) if t.is_floating_point() else t)(torch.as_tensor(a)))
    def _A_setup():
        B, Sq, D = 4, 1, 512
        Hq, Hkv, Sk, Dh = 32, 32, 4096, 128
        assert Hq % Hkv == 0, (Hq, Hkv)
        return {
            "x": _w((lambda *s: torch.randn(*s, dtype=torch.bfloat16) * 0.05)(B, Sq, D)),
            "k_cache": _w((lambda *s: torch.randn(*s, dtype=torch.bfloat16) * 1.6)(B, Hkv, Sk, Dh)),
            "v_cache": _w((lambda *s: torch.randn(*s, dtype=torch.bfloat16) * 0.8)(B, Hkv, Sk, Dh)),
            "wq": _w((lambda *s: torch.randn(*s, dtype=torch.bfloat16) * 1.6)(D, Hq * Dh) * (D ** -0.5)),
            "wo": _w((lambda *s: torch.randn(*s, dtype=torch.bfloat16) * 0.8)(Hq * Dh, D) * ((Hq * Dh) ** -0.5)),
        }
    _A_in = _A_setup()

    def _B_setup():
        B, S, D, F = 4, 1, 512, 1376
        return {
            "x": _w((lambda *s: torch.randn(*s, dtype=torch.bfloat16) * 0.05)(B, S, D)),
            "w_gate": _w((lambda *s: torch.randn(*s, dtype=torch.bfloat16) * 0.4)(D, F) * (D ** -0.5)),
            "w_up": _w((lambda *s: torch.randn(*s, dtype=torch.bfloat16) * 0.4)(D, F) * (D ** -0.5)),
            "w_down": _w((lambda *s: torch.randn(*s, dtype=torch.bfloat16) * 0.4)(F, D) * (F ** -0.5)),
        }
    _B_in = _B_setup()

    return {
        "A_x": _A_in["x"],
        "A_k_cache": _A_in["k_cache"],
        "A_v_cache": _A_in["v_cache"],
        "A_wq": _A_in["wq"],
        "A_wo": _A_in["wo"],
        "B_x": _B_in["x"],
        "B_w_gate": _B_in["w_gate"],
        "B_w_up": _B_in["w_up"],
        "B_w_down": _B_in["w_down"],
    }

def reference(A_x, A_k_cache, A_v_cache, A_wq, A_wo, B_x, B_w_gate, B_w_up, B_w_down):
    def _A_ref(x, k_cache, v_cache, wq, wo):
        B, Sq, D = x.shape
        Hq, Dh = 32, 128
        Hkv, Sk = k_cache.shape[1], k_cache.shape[2]
        W = min(4096, max(256, Sk // 4))
        rep = Hq // Hkv
        q = (lambda x, *d: x.permute(*d))((x @ wq).reshape(B, Sq, Hq, Dh), 0, 2, 1, 3)
        k = (lambda x, n, axis: torch.repeat_interleave(x, n, dim=axis))(k_cache[:, :, Sk - W:, :], rep, axis=1)
        v = (lambda x, n, axis: torch.repeat_interleave(x, n, dim=axis))(v_cache[:, :, Sk - W:, :], rep, axis=1)
        scores = torch.einsum("bhqd,bhkd->bhqk", q, k) * (Dh ** -0.5)
        p = _softmax(scores, axis=-1)
        o = torch.einsum("bhqk,bhkd->bhqd", p, v)
        return (lambda x, *d: x.permute(*d))(o, 0, 2, 1, 3).reshape(B, Sq, Hq * Dh) @ wo

    def _B_ref(x, w_gate, w_up, w_down):
        g = torch.einsum("bsd,df->bsf", x, w_gate)
        u = torch.einsum("bsd,df->bsf", x, w_up)
        h = g * u
        return torch.einsum("bsf,fd->bsd", h, w_down)

    x = A_x
    h = x + _A_ref(_layernorm(x, axis=-1), A_k_cache, A_v_cache, A_wq, A_wo)
    h2 = h + _B_ref(_layernorm(h, axis=-1), B_w_gate, B_w_up, B_w_down)
    return h2
```

```asm
; @launch grid=(256,1,1) block=(512,1,1) lds=139776
.amdgcn_target "amdgcn-amd-amdhsa--gfx950"
.text
.globl sequential_preLN__sliding_block_cached__glu_gated_bilinear__decode_kernel
.p2align 8
.type sequential_preLN__sliding_block_cached__glu_gated_bilinear__decode_kernel,@function
sequential_preLN__sliding_block_cached__glu_gated_bilinear__decode_kernel:
    s_cmp_ge_u32 s2, 256
    s_cbranch_scc1 L_end
    s_load_dwordx16 s[16:31], s[0:1], 0
    s_load_dwordx8 s[32:39], s[0:1], 64
    v_lshrrev_b32 v4, 6, v0
    v_and_b32 v1, 63, v0
    v_readfirstlane_b32 s3, v4
    s_and_b32 s9, s2, 7
    s_lshr_b32 s10, s2, 3
    s_and_b32 s12, s10, 3
    s_add_u32 s4, s9, 0
    s_and_b32 s4, s4, 7
    s_lshl_b32 s4, s4, 2
    s_add_u32 s4, s4, s12
    s_lshr_b32 s7, s10, 2
    s_and_b32 s5, s7, 3
    s_lshr_b32 s6, s7, 2
    v_lshrrev_b32 v10, 4, v1
    v_and_b32 v11, 15, v1
    v_and_b32 v4, 3, v1
    v_lshrrev_b32 v6, 2, v11
    v_lshlrev_b32 v5, 4, v4
    v_lshl_add_u32 v5, v10, 6, v5
    v_lshl_add_u32 v2, v6, 8, v5
    v_lshlrev_b32 v5, 4, v11
    v_lshl_add_u32 v3, v10, 10, v5
    s_mov_b32 s78, 0x3f803f80
    s_mov_b32 s61, 0xff
    s_getreg_b32 s60, hwreg(HW_REG_XCC_ID, 0, 4)
    s_lshl_b32 s12, s5, 5
    s_add_u32 s12, s12, s4
    s_lshl_b32 s12, s12, 20
    s_lshl_b32 s13, s6, 17
    s_add_u32 s12, s12, s13
    s_add_u32 s12, s12, 786432
    s_lshl_b32 s13, s4, 8
    s_lshl_b32 s14, s7, 19
    s_add_u32 s13, s13, s14
    s_waitcnt lgkmcnt(0)
    s_lshr_b32 s37, s9, 1
    s_mul_i32 s27, s37, 22
    s_add_u32 s27, s27, s10
    s_cmp_lt_u32 s10, 22
    s_cselect_b32 s26, 1, 0
    s_cmp_lt_u32 s27, 86
    s_cselect_b32 s26, s26, 0
    s_bitcmp1_b32 s9, 0
    s_cselect_b32 s26, 0, s26
    s_lshl_b32 s36, s10, 2
    s_add_u32 s36, s36, s37
    s_bitcmp1_b32 s9, 0
    s_cselect_b32 s36, s36, 0x1000
    s_mov_b32 s48, s38
    s_mov_b32 s49, s39
    s_mov_b32 s50, 2097152
    s_mov_b32 s51, 0x20000
    s_mov_b32 s52, s16
    s_mov_b32 s53, s17
    s_mov_b32 s54, 4096
    s_mov_b32 s55, 0x20000
    s_cmp_lg_u32 s3, 0
    s_cbranch_scc1 L_other
    s_add_u32 s56, s22, s13
    s_addc_u32 s57, s23, 0
    s_mov_b32 s58, 516352
    s_mov_b32 s59, 0x20000
    v_mov_b32 v7, 0
    buffer_load_dword v40, v7, s[48:51], 0 offen sc1
    v_lshl_add_u32 v5, v10, 2, v6
    v_lshlrev_b32 v5, 4, v5
    v_lshl_add_u32 v7, v4, 10, v5
    buffer_load_dwordx4 v[16:19], v7, s[52:55], 0 offen offset:0
    buffer_load_dwordx4 v[20:23], v7, s[52:55], 0 offen offset:256
    buffer_load_dwordx4 v[24:27], v7, s[52:55], 0 offen offset:512
    buffer_load_dwordx4 v[28:31], v7, s[52:55], 0 offen offset:768
    v_lshlrev_b32 v5, 4, v10
    v_lshl_add_u32 v8, v4, 10, v5
    s_lshl_b32 s14, s7, 7
    buffer_load_dwordx4 v[32:35], v8, s[52:55], s14 offen
    buffer_load_dwordx4 v[36:39], v8, s[52:55], s14 offen offset:64
    v_lshlrev_b32 v5, 1, v10
    v_xor_b32 v5, v5, v11
    v_lshlrev_b32 v5, 4, v5
    v_lshl_add_u32 v9, v10, 13, v5
    v_xor_b32 v8, 128, v9
    s_mov_b32 s14, 0
    s_mov_b32 m0, 24576
    s_nop 0
    buffer_load_dwordx4 v9, s[56:59], s14 offen nt lds
    s_add_u32 s14, s14, 32768
    s_add_u32 m0, m0, 1024
    s_nop 0
    buffer_load_dwordx4 v9, s[56:59], s14 offen nt lds
    s_add_u32 s14, s14, 32768
    s_add_u32 m0, m0, 1024
    s_nop 0
    buffer_load_dwordx4 v8, s[56:59], s14 offen nt lds
    s_add_u32 s14, s14, 32768
    s_add_u32 m0, m0, 1024
    s_nop 0
    buffer_load_dwordx4 v8, s[56:59], s14 offen nt lds
    s_add_u32 s14, s14, 32768
    s_add_u32 m0, m0, 1024
    s_nop 0
    buffer_load_dwordx4 v9, s[56:59], s14 offen nt lds
    s_add_u32 s14, s14, 32768
    s_add_u32 m0, m0, 1024
    s_nop 0
    buffer_load_dwordx4 v9, s[56:59], s14 offen nt lds
    s_add_u32 s14, s14, 32768
    s_add_u32 m0, m0, 1024
    s_nop 0
    buffer_load_dwordx4 v8, s[56:59], s14 offen nt lds
    s_add_u32 s14, s14, 32768
    s_add_u32 m0, m0, 1024
    s_nop 0
    buffer_load_dwordx4 v8, s[56:59], s14 offen nt lds
    s_add_u32 s14, s14, 32768
    s_add_u32 m0, m0, 1024
    s_nop 0
    buffer_load_dwordx4 v9, s[56:59], s14 offen nt lds
    s_add_u32 s14, s14, 32768
    s_add_u32 m0, m0, 1024
    s_nop 0
    buffer_load_dwordx4 v9, s[56:59], s14 offen nt lds
    s_add_u32 s14, s14, 32768
    s_add_u32 m0, m0, 1024
    s_nop 0
    buffer_load_dwordx4 v8, s[56:59], s14 offen nt lds
    s_add_u32 s14, s14, 32768
    s_add_u32 m0, m0, 1024
    s_nop 0
    buffer_load_dwordx4 v8, s[56:59], s14 offen nt lds
    s_add_u32 s14, s14, 32768
    s_add_u32 m0, m0, 1024
    s_nop 0
    buffer_load_dwordx4 v9, s[56:59], s14 offen nt lds
    s_add_u32 s14, s14, 32768
    s_add_u32 m0, m0, 1024
    s_nop 0
    buffer_load_dwordx4 v9, s[56:59], s14 offen nt lds
    s_add_u32 s14, s14, 32768
    s_add_u32 m0, m0, 1024
    s_nop 0
    buffer_load_dwordx4 v8, s[56:59], s14 offen nt lds
    s_add_u32 s14, s14, 32768
    s_add_u32 m0, m0, 1024
    s_nop 0
    buffer_load_dwordx4 v8, s[56:59], s14 offen nt lds
    s_add_u32 s40, s18, s12
    s_addc_u32 s41, s19, 0
    s_mov_b32 s42, 131072
    s_mov_b32 s43, 0x20000
    s_add_u32 s44, s20, s12
    s_addc_u32 s45, s21, 0
    s_mov_b32 s46, 131072
    s_mov_b32 s47, 0x20000
    s_lshl_b32 s12, s3, 14
    s_add_u32 s13, s12, 4096
    s_add_u32 s14, s12, 8192
    s_add_u32 s15, s12, 12288
    buffer_load_dwordx4 v[96:99], v2, s[40:43], s12 offen offset:0 nt
    buffer_load_dwordx4 v[100:103], v2, s[40:43], s12 offen offset:1024 nt
    buffer_load_dwordx4 v[104:107], v2, s[40:43], s12 offen offset:2048 nt
    buffer_load_dwordx4 v[108:111], v2, s[40:43], s12 offen offset:3072 nt
    buffer_load_dwordx4 v[112:115], v2, s[40:43], s13 offen offset:0 nt
    buffer_load_dwordx4 v[116:119], v2, s[40:43], s13 offen offset:1024 nt
    buffer_load_dwordx4 v[120:123], v2, s[40:43], s13 offen offset:2048 nt
    buffer_load_dwordx4 v[124:127], v2, s[40:43], s13 offen offset:3072 nt
    buffer_load_dwordx4 v[128:131], v2, s[40:43], s14 offen offset:0 nt
    buffer_load_dwordx4 v[132:135], v2, s[40:43], s14 offen offset:1024 nt
    buffer_load_dwordx4 v[136:139], v2, s[40:43], s14 offen offset:2048 nt
    buffer_load_dwordx4 v[140:143], v2, s[40:43], s14 offen offset:3072 nt
    buffer_load_dwordx4 v[144:147], v2, s[40:43], s15 offen offset:0 nt
    buffer_load_dwordx4 v[148:151], v2, s[40:43], s15 offen offset:1024 nt
    buffer_load_dwordx4 v[152:155], v2, s[40:43], s15 offen offset:2048 nt
    buffer_load_dwordx4 v[156:159], v2, s[40:43], s15 offen offset:3072 nt
    buffer_load_dwordx4 v[160:163], v3, s[44:47], s12 offen offset:0 nt
    buffer_load_dwordx4 v[164:167], v3, s[44:47], s12 offen offset:256 nt
    buffer_load_dwordx4 v[168:171], v3, s[44:47], s12 offen offset:512 nt
    buffer_load_dwordx4 v[172:175], v3, s[44:47], s12 offen offset:768 nt
    buffer_load_dwordx4 v[176:179], v3, s[44:47], s13 offen offset:0 nt
    buffer_load_dwordx4 v[180:183], v3, s[44:47], s13 offen offset:256 nt
    buffer_load_dwordx4 v[184:187], v3, s[44:47], s13 offen offset:512 nt
    buffer_load_dwordx4 v[188:191], v3, s[44:47], s13 offen offset:768 nt
    buffer_load_dwordx4 v[192:195], v3, s[44:47], s14 offen offset:0 nt
    buffer_load_dwordx4 v[196:199], v3, s[44:47], s14 offen offset:256 nt
    buffer_load_dwordx4 v[200:203], v3, s[44:47], s14 offen offset:512 nt
    buffer_load_dwordx4 v[204:207], v3, s[44:47], s14 offen offset:768 nt
    buffer_load_dwordx4 v[208:211], v3, s[44:47], s15 offen offset:0 nt
    buffer_load_dwordx4 v[212:215], v3, s[44:47], s15 offen offset:256 nt
    buffer_load_dwordx4 v[216:219], v3, s[44:47], s15 offen offset:512 nt
    buffer_load_dwordx4 v[220:223], v3, s[44:47], s15 offen offset:768 nt
    s_barrier
    s_mov_b32 s64, 0xf000f
    s_mov_b32 s65, 0xf000f
    s_mov_b32 s66, 0xf000f0
    s_mov_b32 s67, 0xf000f0
    s_mov_b32 s68, 0xf000f00
    s_mov_b32 s69, 0xf000f00
    s_mov_b32 s70, 0xf000f000
    s_mov_b32 s71, 0xf000f000
    s_mov_b32 s72, 0x22222222
    s_mov_b32 s73, 0x22222222
    s_mov_b32 s74, 0x44444444
    s_mov_b32 s75, 0x44444444
    s_mov_b32 s76, 0x88888888
    s_mov_b32 s77, 0x88888888
    s_waitcnt vmcnt(48)
    v_readfirstlane_b32 s62, v40
    v_dot2_f32_bf16 v42, v16, s78, 0
    v_dot2_f32_bf16 v43, v16, v16, 0
    v_dot2_f32_bf16 v44, v17, s78, 0
    v_dot2_f32_bf16 v45, v17, v17, 0
    v_dot2_f32_bf16 v42, v18, s78, v42
    v_dot2_f32_bf16 v43, v18, v18, v43
    v_dot2_f32_bf16 v44, v19, s78, v44
    v_dot2_f32_bf16 v45, v19, v19, v45
    v_dot2_f32_bf16 v42, v20, s78, v42
    v_dot2_f32_bf16 v43, v20, v20, v43
    v_dot2_f32_bf16 v44, v21, s78, v44
    v_dot2_f32_bf16 v45, v21, v21, v45
    v_dot2_f32_bf16 v42, v22, s78, v42
    v_dot2_f32_bf16 v43, v22, v22, v43
    v_dot2_f32_bf16 v44, v23, s78, v44
    v_dot2_f32_bf16 v45, v23, v23, v45
    v_dot2_f32_bf16 v42, v24, s78, v42
    v_dot2_f32_bf16 v43, v24, v24, v43
    v_dot2_f32_bf16 v44, v25, s78, v44
    v_dot2_f32_bf16 v45, v25, v25, v45
    v_dot2_f32_bf16 v42, v26, s78, v42
    v_dot2_f32_bf16 v43, v26, v26, v43
    v_dot2_f32_bf16 v44, v27, s78, v44
    v_dot2_f32_bf16 v45, v27, v27, v45
    v_dot2_f32_bf16 v42, v28, s78, v42
    v_dot2_f32_bf16 v43, v28, v28, v43
    v_dot2_f32_bf16 v44, v29, s78, v44
    v_dot2_f32_bf16 v45, v29, v29, v45
    v_dot2_f32_bf16 v42, v30, s78, v42
    v_dot2_f32_bf16 v43, v30, v30, v43
    v_dot2_f32_bf16 v44, v31, s78, v44
    v_dot2_f32_bf16 v45, v31, v31, v45
    s_mul_i32 s8, s62, 0x9E3779B1
    s_add_u32 s8, s8, 0x7F4A7C15
    v_add_f32 v42, v42, v44
    v_add_f32 v43, v43, v45
    s_nop 0
    v_add_f32_dpp v42, v42, v42 row_ror:4 row_mask:0xf bank_mask:0xf
    v_add_f32_dpp v43, v43, v43 row_ror:4 row_mask:0xf bank_mask:0xf
    s_nop 0
    v_add_f32_dpp v42, v42, v42 row_ror:8 row_mask:0xf bank_mask:0xf
    v_add_f32_dpp v43, v43, v43 row_ror:8 row_mask:0xf bank_mask:0xf
    v_mov_b32 v44, v42
    s_nop 1
    v_permlane16_swap_b32 v42, v44
    v_add_f32 v42, v42, v44
    v_mov_b32 v44, v42
    s_nop 1
    v_permlane32_swap_b32 v42, v44
    v_add_f32 v42, v42, v44
    v_mov_b32 v45, v43
    s_nop 1
    v_permlane16_swap_b32 v43, v45
    v_add_f32 v43, v43, v45
    v_mov_b32 v45, v43
    s_nop 1
    v_permlane32_swap_b32 v43, v45
    v_add_f32 v43, v43, v45
    v_mul_f32 v42, 0x3b000000, v42
    v_mul_f32 v43, 0x3b000000, v43
    v_fma_f32 v43, -v42, v42, v43
    v_max_f32 v43, 0, v43
    v_cvt_pk_bf16_f32 v42, v42, v42
    v_and_b32 v42, 0xffff0000, v42
    v_cvt_pk_bf16_f32 v43, v43, v43
    v_and_b32 v43, 0xffff0000, v43
    v_add_f32 v43, 0x3727c5ac, v43
    v_cvt_pk_bf16_f32 v43, v43, v43
    v_and_b32 v43, 0xffff0000, v43
    v_sqrt_f32 v43, v43
    s_nop 0
    v_cvt_pk_bf16_f32 v43, v43, v43
    v_and_b32 v43, 0xffff0000, v43
    v_rcp_f32 v43, v43
    v_lshlrev_b32 v16, 16, v32
    v_and_b32 v17, 0xffff0000, v32
    v_lshlrev_b32 v18, 16, v33
    v_and_b32 v19, 0xffff0000, v33
    v_lshlrev_b32 v20, 16, v34
    v_and_b32 v21, 0xffff0000, v34
    v_lshlrev_b32 v22, 16, v35
    v_and_b32 v23, 0xffff0000, v35
    v_lshlrev_b32 v24, 16, v36
    v_and_b32 v25, 0xffff0000, v36
    v_lshlrev_b32 v26, 16, v37
    v_and_b32 v27, 0xffff0000, v37
    v_lshlrev_b32 v28, 16, v38
    v_and_b32 v29, 0xffff0000, v38
    v_lshlrev_b32 v30, 16, v39
    v_and_b32 v31, 0xffff0000, v39
    v_sub_f32 v16, v16, v42
    v_sub_f32 v17, v17, v42
    v_sub_f32 v18, v18, v42
    v_sub_f32 v19, v19, v42
    v_sub_f32 v20, v20, v42
    v_sub_f32 v21, v21, v42
    v_sub_f32 v22, v22, v42
    v_sub_f32 v23, v23, v42
    v_sub_f32 v24, v24, v42
    v_sub_f32 v25, v25, v42
    v_sub_f32 v26, v26, v42
    v_sub_f32 v27, v27, v42
    v_sub_f32 v28, v28, v42
    v_sub_f32 v29, v29, v42
    v_sub_f32 v30, v30, v42
    v_sub_f32 v31, v31, v42
    v_cvt_pk_bf16_f32 v32, v16, v17
    v_cvt_pk_bf16_f32 v33, v18, v19
    v_cvt_pk_bf16_f32 v34, v20, v21
    v_cvt_pk_bf16_f32 v35, v22, v23
    v_cvt_pk_bf16_f32 v36, v24, v25
    v_cvt_pk_bf16_f32 v37, v26, v27
    v_cvt_pk_bf16_f32 v38, v28, v29
    v_cvt_pk_bf16_f32 v39, v30, v31
    v_lshlrev_b32 v16, 16, v32
    v_and_b32 v17, 0xffff0000, v32
    v_lshlrev_b32 v18, 16, v33
    v_and_b32 v19, 0xffff0000, v33
    v_lshlrev_b32 v20, 16, v34
    v_and_b32 v21, 0xffff0000, v34
    v_lshlrev_b32 v22, 16, v35
    v_and_b32 v23, 0xffff0000, v35
    v_lshlrev_b32 v24, 16, v36
    v_and_b32 v25, 0xffff0000, v36
    v_lshlrev_b32 v26, 16, v37
    v_and_b32 v27, 0xffff0000, v37
    v_lshlrev_b32 v28, 16, v38
    v_and_b32 v29, 0xffff0000, v38
    v_lshlrev_b32 v30, 16, v39
    v_and_b32 v31, 0xffff0000, v39
    v_mul_f32 v16, v16, v43
    v_mul_f32 v17, v17, v43
    v_mul_f32 v18, v18, v43
    v_mul_f32 v19, v19, v43
    v_mul_f32 v20, v20, v43
    v_mul_f32 v21, v21, v43
    v_mul_f32 v22, v22, v43
    v_mul_f32 v23, v23, v43
    v_mul_f32 v24, v24, v43
    v_mul_f32 v25, v25, v43
    v_mul_f32 v26, v26, v43
    v_mul_f32 v27, v27, v43
    v_mul_f32 v28, v28, v43
    v_mul_f32 v29, v29, v43
    v_mul_f32 v30, v30, v43
    v_mul_f32 v31, v31, v43
    v_cvt_pk_bf16_f32 v32, v16, v17
    v_cvt_pk_bf16_f32 v33, v18, v19
    v_cvt_pk_bf16_f32 v34, v20, v21
    v_cvt_pk_bf16_f32 v35, v22, v23
    v_cvt_pk_bf16_f32 v36, v24, v25
    v_cvt_pk_bf16_f32 v37, v26, v27
    v_cvt_pk_bf16_f32 v38, v28, v29
    v_cvt_pk_bf16_f32 v39, v30, v31
    v_cndmask_b32 v48, 0, v32, s[64:65]
    v_cndmask_b32 v49, 0, v33, s[64:65]
    v_cndmask_b32 v50, 0, v34, s[64:65]
    v_cndmask_b32 v51, 0, v35, s[64:65]
    v_cndmask_b32 v52, 0, v36, s[64:65]
    v_cndmask_b32 v53, 0, v37, s[64:65]
    v_cndmask_b32 v54, 0, v38, s[64:65]
    v_cndmask_b32 v55, 0, v39, s[64:65]
    v_cndmask_b32 v56, 0, v32, s[66:67]
    v_cndmask_b32 v57, 0, v33, s[66:67]
    v_cndmask_b32 v58, 0, v34, s[66:67]
    v_cndmask_b32 v59, 0, v35, s[66:67]
    v_cndmask_b32 v60, 0, v36, s[66:67]
    v_cndmask_b32 v61, 0, v37, s[66:67]
    v_cndmask_b32 v62, 0, v38, s[66:67]
    v_cndmask_b32 v63, 0, v39, s[66:67]
    v_cndmask_b32 v64, 0, v32, s[68:69]
    v_cndmask_b32 v65, 0, v33, s[68:69]
    v_cndmask_b32 v66, 0, v34, s[68:69]
    v_cndmask_b32 v67, 0, v35, s[68:69]
    v_cndmask_b32 v68, 0, v36, s[68:69]
    v_cndmask_b32 v69, 0, v37, s[68:69]
    v_cndmask_b32 v70, 0, v38, s[68:69]
    v_cndmask_b32 v71, 0, v39, s[68:69]
    v_cndmask_b32 v72, 0, v32, s[70:71]
    v_cndmask_b32 v73, 0, v33, s[70:71]
    v_cndmask_b32 v74, 0, v34, s[70:71]
    v_cndmask_b32 v75, 0, v35, s[70:71]
    v_cndmask_b32 v76, 0, v36, s[70:71]
    v_cndmask_b32 v77, 0, v37, s[70:71]
    v_cndmask_b32 v78, 0, v38, s[70:71]
    v_cndmask_b32 v79, 0, v39, s[70:71]
    v_lshrrev_b32 v6, 2, v11
    v_lshl_add_u32 v5, v10, 3, v6
    v_lshlrev_b32 v5, 8, v5
    v_and_b32 v7, 1, v10
    v_lshl_add_u32 v7, v7, 2, v6
    v_lshl_add_u32 v5, v7, 5, v5
    v_lshl_add_u32 v5, v4, 3, v5
    v_add_u32 v88, 24576, v5
    v_xor_b32 v89, 32, v88
    v_xor_b32 v90, 64, v88
    v_xor_b32 v91, 96, v88
    v_xor_b32 v92, 128, v88
    v_xor_b32 v93, 160, v88
    v_xor_b32 v94, 192, v88
    v_xor_b32 v95, 224, v88
    v_lshlrev_b32 v5, 4, v10
    v_lshl_add_u32 v5, v6, 6, v5
    v_lshl_add_u32 v9, v4, 12, v5
    s_lshl_b32 s62, s4, 14
    s_lshl_b32 s63, s7, 9
    s_add_u32 s63, s63, s62
    s_add_u32 s63, s63, 589824
    v_mov_b32 v232, s8
    s_lshr_b32 s14, s8, 8
    v_mov_b32 v233, s14
    s_lshr_b32 s14, s8, 16
    v_mov_b32 v234, s14
    s_lshr_b32 s14, s8, 24
    v_mov_b32 v235, s14
    s_and_b32 s14, s14, 0xf0
    s_or_b32 s14, s14, s60
    v_mov_b32 v236, s14
    s_waitcnt vmcnt(32)
    ds_read_b64_tr_b16 v[16:17], v88 offset:0
    ds_read_b64_tr_b16 v[18:19], v88 offset:1024
    ds_read_b64_tr_b16 v[20:21], v88 offset:8192
    ds_read_b64_tr_b16 v[22:23], v88 offset:9216
    ds_read_b64_tr_b16 v[24:25], v89 offset:0
    ds_read_b64_tr_b16 v[26:27], v89 offset:1024
    ds_read_b64_tr_b16 v[28:29], v89 offset:8192
    ds_read_b64_tr_b16 v[30:31], v89 offset:9216
    ds_read_b64_tr_b16 v[32:33], v90 offset:0
    ds_read_b64_tr_b16 v[34:35], v90 offset:1024
    ds_read_b64_tr_b16 v[36:37], v90 offset:8192
    ds_read_b64_tr_b16 v[38:39], v90 offset:9216
    ds_read_b64_tr_b16 v[40:41], v91 offset:0
    ds_read_b64_tr_b16 v[42:43], v91 offset:1024
    ds_read_b64_tr_b16 v[44:45], v91 offset:8192
    ds_read_b64_tr_b16 v[46:47], v91 offset:9216
    s_waitcnt lgkmcnt(8)
    v_mfma_f32_16x16x32_bf16 v[80:83], v[16:19], v[48:51], 0
    v_mfma_f32_16x16x32_bf16 v[80:83], v[20:23], v[52:55], v[80:83]
    v_mfma_f32_16x16x32_bf16 v[80:83], v[24:27], v[56:59], v[80:83]
    v_mfma_f32_16x16x32_bf16 v[80:83], v[28:31], v[60:63], v[80:83]
    s_nop 7
    ds_read_b64_tr_b16 v[16:17], v92 offset:0
    ds_read_b64_tr_b16 v[18:19], v92 offset:1024
    ds_read_b64_tr_b16 v[20:21], v92 offset:8192
    ds_read_b64_tr_b16 v[22:23], v92 offset:9216
    ds_read_b64_tr_b16 v[24:25], v93 offset:0
    ds_read_b64_tr_b16 v[26:27], v93 offset:1024
    ds_read_b64_tr_b16 v[28:29], v93 offset:8192
    ds_read_b64_tr_b16 v[30:31], v93 offset:9216
    s_waitcnt lgkmcnt(8)
    v_mfma_f32_16x16x32_bf16 v[80:83], v[32:35], v[64:67], v[80:83]
    v_mfma_f32_16x16x32_bf16 v[80:83], v[36:39], v[68:71], v[80:83]
    v_mfma_f32_16x16x32_bf16 v[80:83], v[40:43], v[72:75], v[80:83]
    v_mfma_f32_16x16x32_bf16 v[80:83], v[44:47], v[76:79], v[80:83]
    s_nop 7
    ds_read_b64_tr_b16 v[32:33], v94 offset:0
    ds_read_b64_tr_b16 v[34:35], v94 offset:1024
    ds_read_b64_tr_b16 v[36:37], v94 offset:8192
    ds_read_b64_tr_b16 v[38:39], v94 offset:9216
    ds_read_b64_tr_b16 v[40:41], v95 offset:0
    ds_read_b64_tr_b16 v[42:43], v95 offset:1024
    ds_read_b64_tr_b16 v[44:45], v95 offset:8192
    ds_read_b64_tr_b16 v[46:47], v95 offset:9216
    s_waitcnt lgkmcnt(8)
    v_mfma_f32_16x16x32_bf16 v[84:87], v[16:19], v[48:51], 0
    v_mfma_f32_16x16x32_bf16 v[84:87], v[20:23], v[52:55], v[84:87]
    v_mfma_f32_16x16x32_bf16 v[84:87], v[24:27], v[56:59], v[84:87]
    v_mfma_f32_16x16x32_bf16 v[84:87], v[28:31], v[60:63], v[84:87]
    s_waitcnt lgkmcnt(0)
    v_mfma_f32_16x16x32_bf16 v[84:87], v[32:35], v[64:67], v[84:87]
    v_mfma_f32_16x16x32_bf16 v[84:87], v[36:39], v[68:71], v[84:87]
    v_mfma_f32_16x16x32_bf16 v[84:87], v[40:43], v[72:75], v[84:87]
    v_mfma_f32_16x16x32_bf16 v[84:87], v[44:47], v[76:79], v[84:87]
    v_bfi_b32 v16, s61, v232, v80
    v_bfi_b32 v17, s61, v233, v81
    v_bfi_b32 v18, s61, v234, v82
    v_bfi_b32 v19, s61, v236, v83
    s_nop 3
    v_bfi_b32 v20, s61, v232, v84
    v_bfi_b32 v21, s61, v233, v85
    v_bfi_b32 v22, s61, v234, v86
    v_bfi_b32 v23, s61, v236, v87
    buffer_store_dwordx4 v[16:19], v9, s[48:51], s63 offen offset:0 sc1
    buffer_store_dwordx4 v[20:23], v9, s[48:51], s63 offen offset:256 sc1
    v_lshlrev_b32 v9, 4, v1
    s_lshl_b32 s63, s5, 12
    s_add_u32 s62, s62, s63
    s_add_u32 s62, s62, 589824
    s_mov_b32 s11, 40000
Qlp_1:
    s_nop 1
    buffer_load_dwordx4 v[24:27], v9, s[48:51], s62 offen offset:0 sc1
    buffer_load_dwordx4 v[28:31], v9, s[48:51], s62 offen offset:1024 sc1
    buffer_load_dwordx4 v[32:35], v9, s[48:51], s62 offen offset:2048 sc1
    buffer_load_dwordx4 v[36:39], v9, s[48:51], s62 offen offset:3072 sc1
    s_waitcnt vmcnt(0)
    v_xor_b32 v40, v24, v232
    v_xor_b32 v41, v27, v236
    v_bitop3_b32 v40, v40, v25, v233 bitop3:0xf6
    v_bitop3_b32 v40, v40, v26, v234 bitop3:0xf6
    v_bitop3_b32 v40, v40, v28, v232 bitop3:0xf6
    v_bitop3_b32 v40, v40, v29, v233 bitop3:0xf6
    v_bitop3_b32 v40, v40, v30, v234 bitop3:0xf6
    v_bitop3_b32 v41, v41, v31, v236 bitop3:0xf6
    v_bitop3_b32 v40, v40, v32, v232 bitop3:0xf6
    v_bitop3_b32 v40, v40, v33, v233 bitop3:0xf6
    v_bitop3_b32 v40, v40, v34, v234 bitop3:0xf6
    v_bitop3_b32 v41, v41, v35, v236 bitop3:0xf6
    v_bitop3_b32 v40, v40, v36, v232 bitop3:0xf6
    v_bitop3_b32 v40, v40, v37, v233 bitop3:0xf6
    v_bitop3_b32 v40, v40, v38, v234 bitop3:0xf6
    v_bitop3_b32 v41, v41, v39, v236 bitop3:0xf6
    v_and_b32 v42, 0xf0, v41
    v_and_or_b32 v40, v40, s61, v42
    v_cmp_eq_u32 vcc, 0, v40
    s_nop 0
    s_cmp_eq_u64 vcc, -1
    s_cbranch_scc1 Qdn_2
    s_sub_u32 s11, s11, 1
    s_cmp_lg_u32 s11, 0
    s_cbranch_scc1 Qlp_1
Qdn_2:
    s_nop 1
    v_and_b32 v24, 0xffffff00, v24
    v_and_b32 v25, 0xffffff00, v25
    v_and_b32 v26, 0xffffff00, v26
    v_and_b32 v27, 0xffffff00, v27
    v_and_b32 v28, 0xffffff00, v28
    v_and_b32 v29, 0xffffff00, v29
    v_and_b32 v30, 0xffffff00, v30
    v_and_b32 v31, 0xffffff00, v31
    v_and_b32 v32, 0xffffff00, v32
    v_and_b32 v33, 0xffffff00, v33
    v_and_b32 v34, 0xffffff00, v34
    v_and_b32 v35, 0xffffff00, v35
    v_and_b32 v36, 0xffffff00, v36
    v_and_b32 v37, 0xffffff00, v37
    v_and_b32 v38, 0xffffff00, v38
    v_and_b32 v39, 0xffffff00, v39
    v_and_b32 v41, 15, v41
    v_pk_add_f32 v[24:25], v[24:25], v[28:29]
    v_pk_add_f32 v[32:33], v[32:33], v[36:37]
    v_pk_add_f32 v[26:27], v[26:27], v[30:31]
    v_pk_add_f32 v[34:35], v[34:35], v[38:39]
    v_cmp_eq_u32 vcc, 0, v41
    v_pk_add_f32 v[24:25], v[24:25], v[32:33]
    v_pk_add_f32 v[26:27], v[26:27], v[34:35]
    s_cmp_eq_u64 vcc, -1
    s_cselect_b32 s79, 1, 0
    v_permlane32_swap_b32 v24, v26
    v_permlane32_swap_b32 v25, v27
    v_add_f32 v24, v24, v26
    v_add_f32 v25, v25, v27
    v_and_b32 v5, 31, v1
    v_lshrrev_b32 v6, 5, v1
    v_lshlrev_b32 v5, 3, v5
    v_lshl_add_u32 v5, v6, 2, v5
    v_cvt_pk_bf16_f32 v24, v24, v25
    ds_write_b32 v5, v24 offset:64
    v_mov_b32 v20, 1
    v_mov_b32 v21, s8
    v_mov_b32 v4, 0
    s_mov_b64 exec, 1
    ds_write_b64 v4, v[20:21] offset:0
    s_mov_b64 exec, -1
    s_branch L_commonA
L_other:
    s_nop 1
    s_add_u32 s40, s18, s12
    s_addc_u32 s41, s19, 0
    s_mov_b32 s42, 131072
    s_mov_b32 s43, 0x20000
    s_add_u32 s44, s20, s12
    s_addc_u32 s45, s21, 0
    s_mov_b32 s46, 131072
    s_mov_b32 s47, 0x20000
    s_lshl_b32 s12, s3, 14
    s_add_u32 s13, s12, 4096
    s_add_u32 s14, s12, 8192
    s_add_u32 s15, s12, 12288
    s_cmp_lg_u32 s3, 1
    s_cbranch_scc1 Lz_3
    v_mov_b32 v16, 0
    v_mov_b32 v17, 0
    v_mov_b32 v18, 0
    v_mov_b32 v19, 0
    v_mov_b32 v7, 0
    ds_write_b128 v7, v[16:19] offset:0
    s_waitcnt lgkmcnt(0)
Lz_3:
    s_cmp_ge_u32 s3, 4
    s_cbranch_scc1 L_hi
    s_barrier
    buffer_load_dwordx4 v[96:99], v2, s[40:43], s12 offen offset:0 nt
    buffer_load_dwordx4 v[100:103], v2, s[40:43], s12 offen offset:1024 nt
    buffer_load_dwordx4 v[104:107], v2, s[40:43], s12 offen offset:2048 nt
    buffer_load_dwordx4 v[108:111], v2, s[40:43], s12 offen offset:3072 nt
    buffer_load_dwordx4 v[112:115], v2, s[40:43], s13 offen offset:0 nt
    buffer_load_dwordx4 v[116:119], v2, s[40:43], s13 offen offset:1024 nt
    buffer_load_dwordx4 v[120:123], v2, s[40:43], s13 offen offset:2048 nt
    buffer_load_dwordx4 v[124:127], v2, s[40:43], s13 offen offset:3072 nt
    buffer_load_dwordx4 v[128:131], v2, s[40:43], s14 offen offset:0 nt
    buffer_load_dwordx4 v[132:135], v2, s[40:43], s14 offen offset:1024 nt
    buffer_load_dwordx4 v[136:139], v2, s[40:43], s14 offen offset:2048 nt
    buffer_load_dwordx4 v[140:143], v2, s[40:43], s14 offen offset:3072 nt
    buffer_load_dwordx4 v[144:147], v2, s[40:43], s15 offen offset:0 nt
    buffer_load_dwordx4 v[148:151], v2, s[40:43], s15 offen offset:1024 nt
    buffer_load_dwordx4 v[152:155], v2, s[40:43], s15 offen offset:2048 nt
    buffer_load_dwordx4 v[156:159], v2, s[40:43], s15 offen offset:3072 nt
    buffer_load_dwordx4 v[160:163], v3, s[44:47], s12 offen offset:0 nt
    buffer_load_dwordx4 v[164:167], v3, s[44:47], s12 offen offset:256 nt
    buffer_load_dwordx4 v[168:171], v3, s[44:47], s12 offen offset:512 nt
    buffer_load_dwordx4 v[172:175], v3, s[44:47], s12 offen offset:768 nt
    buffer_load_dwordx4 v[176:179], v3, s[44:47], s13 offen offset:0 nt
    buffer_load_dwordx4 v[180:183], v3, s[44:47], s13 offen offset:256 nt
    buffer_load_dwordx4 v[184:187], v3, s[44:47], s13 offen offset:512 nt
    buffer_load_dwordx4 v[188:191], v3, s[44:47], s13 offen offset:768 nt
    buffer_load_dwordx4 v[192:195], v3, s[44:47], s14 offen offset:0 nt
    buffer_load_dwordx4 v[196:199], v3, s[44:47], s14 offen offset:256 nt
    buffer_load_dwordx4 v[200:203], v3, s[44:47], s14 offen offset:512 nt
    buffer_load_dwordx4 v[204:207], v3, s[44:47], s14 offen offset:768 nt
    buffer_load_dwordx4 v[208:211], v3, s[44:47], s15 offen offset:0 nt
    buffer_load_dwordx4 v[212:215], v3, s[44:47], s15 offen offset:256 nt
    buffer_load_dwordx4 v[216:219], v3, s[44:47], s15 offen offset:512 nt
    buffer_load_dwordx4 v[220:223], v3, s[44:47], s15 offen offset:768 nt
    s_mov_b32 s64, 0xf000f
    s_mov_b32 s65, 0xf000f
    s_mov_b32 s66, 0xf000f0
    s_mov_b32 s67, 0xf000f0
    s_mov_b32 s68, 0xf000f00
    s_mov_b32 s69, 0xf000f00
    s_mov_b32 s70, 0xf000f000
    s_mov_b32 s71, 0xf000f000
    s_mov_b32 s72, 0x22222222
    s_mov_b32 s73, 0x22222222
    s_mov_b32 s74, 0x44444444
    s_mov_b32 s75, 0x44444444
    s_mov_b32 s76, 0x88888888
    s_mov_b32 s77, 0x88888888
    s_branch L_commonA
L_hi:
    s_nop 1
    v_and_b32 v5, 1, v10
    v_lshlrev_b32 v5, 1, v5
    v_and_b32 v6, 7, v1
    v_xor_b32 v5, v5, v6
    v_lshlrev_b32 v5, 4, v5
    v_lshrrev_b32 v6, 3, v1
    v_lshl_add_u32 v226, v6, 10, v5
    v_xor_b32 v227, 64, v226
    s_lshl_b32 s62, s4, 17
    s_lshl_b32 s63, s7, 7
    s_add_u32 s62, s62, s63
    s_add_u32 s16, s24, s62
    s_addc_u32 s17, s25, 0
    s_mov_b32 s18, 130176
    s_mov_b32 s19, 0x20000
    s_cmp_lg_u32 s3, 4
    s_cbranch_scc1 Lx_4
    s_cmp_ge_u32 s36, 128
    s_cbranch_scc1 Lx_4
    s_lshl_b32 s62, s36, 3
    v_and_b32 v7, 3, v1
    v_lshlrev_b32 v7, 10, v7
    v_lshl_add_u32 v7, v10, 1, v7
    buffer_load_ushort v224, v7, s[52:55], s62 offen
Lx_4:
    s_barrier
    buffer_load_dwordx4 v[96:99], v2, s[40:43], s12 offen offset:0 nt
    buffer_load_dwordx4 v[100:103], v2, s[40:43], s12 offen offset:1024 nt
    buffer_load_dwordx4 v[104:107], v2, s[40:43], s12 offen offset:2048 nt
    buffer_load_dwordx4 v[108:111], v2, s[40:43], s12 offen offset:3072 nt
    buffer_load_dwordx4 v[112:115], v2, s[40:43], s13 offen offset:0 nt
    buffer_load_dwordx4 v[116:119], v2, s[40:43], s13 offen offset:1024 nt
    buffer_load_dwordx4 v[120:123], v2, s[40:43], s13 offen offset:2048 nt
    buffer_load_dwordx4 v[124:127], v2, s[40:43], s13 offen offset:3072 nt
    buffer_load_dwordx4 v[128:131], v2, s[40:43], s14 offen offset:0 nt
    buffer_load_dwordx4 v[132:135], v2, s[40:43], s14 offen offset:1024 nt
    buffer_load_dwordx4 v[136:139], v2, s[40:43], s14 offen offset:2048 nt
    buffer_load_dwordx4 v[140:143], v2, s[40:43], s14 offen offset:3072 nt
    buffer_load_dwordx4 v[144:147], v2, s[40:43], s15 offen offset:0 nt
    buffer_load_dwordx4 v[148:151], v2, s[40:43], s15 offen offset:1024 nt
    buffer_load_dwordx4 v[152:155], v2, s[40:43], s15 offen offset:2048 nt
    buffer_load_dwordx4 v[156:159], v2, s[40:43], s15 offen offset:3072 nt
    s_sub_u32 s63, s3, 4
    s_lshl_b32 s63, s63, 14
    s_add_u32 m0, s63, 74240
    s_nop 0
    buffer_load_dwordx4 v3, s[44:47], s12 offen offset:0 nt lds
    s_add_u32 m0, s63, 75008
    s_nop 0
    buffer_load_dwordx4 v3, s[44:47], s12 offen offset:256 nt lds
    s_add_u32 m0, s63, 75776
    s_nop 0
    buffer_load_dwordx4 v3, s[44:47], s12 offen offset:512 nt lds
    s_add_u32 m0, s63, 76544
    s_nop 0
    buffer_load_dwordx4 v3, s[44:47], s12 offen offset:768 nt lds
    s_add_u32 m0, s63, 78336
    s_nop 0
    buffer_load_dwordx4 v3, s[44:47], s13 offen offset:0 nt lds
    s_add_u32 m0, s63, 79104
    s_nop 0
    buffer_load_dwordx4 v3, s[44:47], s13 offen offset:256 nt lds
    s_add_u32 m0, s63, 79872
    s_nop 0
    buffer_load_dwordx4 v3, s[44:47], s13 offen offset:512 nt lds
    s_add_u32 m0, s63, 80640
    s_nop 0
    buffer_load_dwordx4 v3, s[44:47], s13 offen offset:768 nt lds
    s_add_u32 m0, s63, 82432
    s_nop 0
    buffer_load_dwordx4 v3, s[44:47], s14 offen offset:0 nt lds
    s_add_u32 m0, s63, 83200
    s_nop 0
    buffer_load_dwordx4 v3, s[44:47], s14 offen offset:256 nt lds
    s_add_u32 m0, s63, 83968
    s_nop 0
    buffer_load_dwordx4 v3, s[44:47], s14 offen offset:512 nt lds
    s_add_u32 m0, s63, 84736
    s_nop 0
    buffer_load_dwordx4 v3, s[44:47], s14 offen offset:768 nt lds
    s_add_u32 m0, s63, 86528
    s_nop 0
    buffer_load_dwordx4 v3, s[44:47], s15 offen offset:0 nt lds
    s_add_u32 m0, s63, 87296
    s_nop 0
    buffer_load_dwordx4 v3, s[44:47], s15 offen offset:256 nt lds
    s_add_u32 m0, s63, 88064
    s_nop 0
    buffer_load_dwordx4 v3, s[44:47], s15 offen offset:512 nt lds
    s_add_u32 m0, s63, 88832
    s_nop 0
    buffer_load_dwordx4 v3, s[44:47], s15 offen offset:768 nt lds
    v_mov_b32 v4, 0
    v_mov_b32 v5, 1
    s_mov_b64 exec, 1
    ds_add_u32 v4, v5 offset:12
    s_mov_b64 exec, -1
    s_mov_b32 s64, 0xf000f
    s_mov_b32 s65, 0xf000f
    s_mov_b32 s66, 0xf000f0
    s_mov_b32 s67, 0xf000f0
    s_mov_b32 s68, 0xf000f00
    s_mov_b32 s69, 0xf000f00
    s_mov_b32 s70, 0xf000f000
    s_mov_b32 s71, 0xf000f000
    s_mov_b32 s72, 0x22222222
    s_mov_b32 s73, 0x22222222
    s_mov_b32 s74, 0x44444444
    s_mov_b32 s75, 0x44444444
    s_mov_b32 s76, 0x88888888
    s_mov_b32 s77, 0x88888888
    s_branch L_commonB
L_commonA:
    s_nop 1
    v_and_b32 v4, 7, v1
    v_and_b32 v5, 1, v4
    v_lshrrev_b32 v4, 1, v4
    v_lshlrev_b32 v5, 4, v5
    v_mov_b32 v6, 0xffff
    v_lshlrev_b32 v6, v5, v6
    v_cmp_eq_u32 vcc, 0, v4
    s_nop 1
    v_cndmask_b32 v12, 0, v6, vcc
    v_cmp_eq_u32 vcc, 1, v4
    s_nop 1
    v_cndmask_b32 v13, 0, v6, vcc
    v_cmp_eq_u32 vcc, 2, v4
    s_nop 1
    v_cndmask_b32 v14, 0, v6, vcc
    v_cmp_eq_u32 vcc, 3, v4
    s_nop 1
    v_cndmask_b32 v15, 0, v6, vcc
    v_and_b32 v4, 3, v1
    v_lshl_add_u32 v9, v10, 2, v4
    v_lshlrev_b32 v9, 4, v9
    v_mov_b32 v4, 0
    s_mov_b32 s11, 320000
Lqlp_6:
    ds_read_b64 v[16:17], v4 offset:0
    s_waitcnt lgkmcnt(0)
    v_readfirstlane_b32 s62, v16
    s_nop 0
    s_cmp_eq_u32 s62, 1
    s_cbranch_scc1 Lqdn_7
    s_sub_u32 s11, s11, 1
    s_cmp_lg_u32 s11, 0
    s_cbranch_scc1 Lqlp_6
Lqdn_7:
    v_readfirstlane_b32 s8, v17
    ds_read_b128 v[20:23], v9 offset:64
    s_nop 0
    v_mov_b32 v232, s8
    s_lshr_b32 s62, s8, 8
    v_mov_b32 v233, s62
    s_lshr_b32 s62, s8, 16
    v_mov_b32 v234, s62
    s_lshr_b32 s62, s8, 24
    v_mov_b32 v235, s62
    s_waitcnt vmcnt(16) lgkmcnt(0)
    v_cndmask_b32 v24, 0, v20, s[64:65]
    v_cndmask_b32 v25, 0, v21, s[64:65]
    v_cndmask_b32 v26, 0, v22, s[64:65]
    v_cndmask_b32 v27, 0, v23, s[64:65]
    v_cndmask_b32 v28, 0, v20, s[66:67]
    v_cndmask_b32 v29, 0, v21, s[66:67]
    v_cndmask_b32 v30, 0, v22, s[66:67]
    v_cndmask_b32 v31, 0, v23, s[66:67]
    v_cndmask_b32 v32, 0, v20, s[68:69]
    v_cndmask_b32 v33, 0, v21, s[68:69]
    v_cndmask_b32 v34, 0, v22, s[68:69]
    v_cndmask_b32 v35, 0, v23, s[68:69]
    v_cndmask_b32 v36, 0, v20, s[70:71]
    v_cndmask_b32 v37, 0, v21, s[70:71]
    v_cndmask_b32 v38, 0, v22, s[70:71]
    v_cndmask_b32 v39, 0, v23, s[70:71]
    v_mfma_f32_16x16x32_bf16 v[40:43], v[24:27], v[96:99], 0
    v_mfma_f32_16x16x32_bf16 v[44:47], v[24:27], v[112:115], 0
    v_mfma_f32_16x16x32_bf16 v[48:51], v[24:27], v[128:131], 0
    v_mfma_f32_16x16x32_bf16 v[52:55], v[24:27], v[144:147], 0
    v_mfma_f32_16x16x32_bf16 v[40:43], v[28:31], v[100:103], v[40:43]
    v_mfma_f32_16x16x32_bf16 v[44:47], v[28:31], v[116:119], v[44:47]
    v_mfma_f32_16x16x32_bf16 v[48:51], v[28:31], v[132:135], v[48:51]
    v_mfma_f32_16x16x32_bf16 v[52:55], v[28:31], v[148:151], v[52:55]
    v_mfma_f32_16x16x32_bf16 v[40:43], v[32:35], v[104:107], v[40:43]
    v_mfma_f32_16x16x32_bf16 v[44:47], v[32:35], v[120:123], v[44:47]
    v_mfma_f32_16x16x32_bf16 v[48:51], v[32:35], v[136:139], v[48:51]
    v_mfma_f32_16x16x32_bf16 v[52:55], v[32:35], v[152:155], v[52:55]
    v_mfma_f32_16x16x32_bf16 v[40:43], v[36:39], v[108:111], v[40:43]
    v_mfma_f32_16x16x32_bf16 v[44:47], v[36:39], v[124:127], v[44:47]
    v_mfma_f32_16x16x32_bf16 v[48:51], v[36:39], v[140:143], v[48:51]
    v_mfma_f32_16x16x32_bf16 v[52:55], v[36:39], v[156:159], v[52:55]
    s_nop 4
    v_mov_b32_dpp v60, v40 quad_perm:[0,0,0,0] row_mask:0xf bank_mask:0xf
    v_mov_b32_dpp v61, v44 quad_perm:[0,0,0,0] row_mask:0xf bank_mask:0xf
    v_mov_b32_dpp v62, v48 quad_perm:[0,0,0,0] row_mask:0xf bank_mask:0xf
    v_mov_b32_dpp v63, v52 quad_perm:[0,0,0,0] row_mask:0xf bank_mask:0xf
    v_add_f32_dpp v60, v41, v60 quad_perm:[1,1,1,1] row_mask:0xf bank_mask:0xf
    v_add_f32_dpp v61, v45, v61 quad_perm:[1,1,1,1] row_mask:0xf bank_mask:0xf
    v_add_f32_dpp v62, v49, v62 quad_perm:[1,1,1,1] row_mask:0xf bank_mask:0xf
    v_add_f32_dpp v63, v53, v63 quad_perm:[1,1,1,1] row_mask:0xf bank_mask:0xf
    v_add_f32_dpp v60, v42, v60 quad_perm:[2,2,2,2] row_mask:0xf bank_mask:0xf
    v_add_f32_dpp v61, v46, v61 quad_perm:[2,2,2,2] row_mask:0xf bank_mask:0xf
    v_add_f32_dpp v62, v50, v62 quad_perm:[2,2,2,2] row_mask:0xf bank_mask:0xf
    v_add_f32_dpp v63, v54, v63 quad_perm:[2,2,2,2] row_mask:0xf bank_mask:0xf
    v_add_f32_dpp v60, v43, v60 quad_perm:[3,3,3,3] row_mask:0xf bank_mask:0xf
    v_add_f32_dpp v61, v47, v61 quad_perm:[3,3,3,3] row_mask:0xf bank_mask:0xf
    v_add_f32_dpp v62, v51, v62 quad_perm:[3,3,3,3] row_mask:0xf bank_mask:0xf
    v_add_f32_dpp v63, v55, v63 quad_perm:[3,3,3,3] row_mask:0xf bank_mask:0xf
    v_cndmask_b32 v65, v60, v61, s[72:73]
    v_cndmask_b32 v65, v65, v62, s[74:75]
    v_cndmask_b32 v65, v65, v63, s[76:77]
    v_cvt_pk_bf16_f32 v65, v65, v65
    v_and_b32 v65, 0xffff0000, v65
    v_mul_f32 v65, 0x3db504f3, v65
    v_cvt_pk_bf16_f32 v65, v65, v65
    v_and_b32 v65, 0xffff0000, v65
    v_mul_f32 v65, 0x3fb8aa3b, v65
    v_mov_b32 v66, v65
    s_nop 1
    v_max_f32_dpp v66, v66, v66 row_ror:8 row_mask:0xf bank_mask:0xf
    s_nop 1
    v_max_f32_dpp v66, v66, v66 row_ror:4 row_mask:0xf bank_mask:0xf
    s_nop 1
    v_max_f32_dpp v66, v66, v66 row_ror:2 row_mask:0xf bank_mask:0xf
    s_nop 1
    v_max_f32_dpp v66, v66, v66 row_ror:1 row_mask:0xf bank_mask:0xf
    v_mov_b32 v4, v66
    s_nop 1
    v_permlane16_swap_b32 v66, v4
    v_max_f32 v66, v66, v4
    v_mov_b32 v4, v66
    s_nop 1
    v_permlane32_swap_b32 v66, v4
    v_max_f32 v66, v66, v4
    v_sub_f32 v65, v65, v66
    v_exp_f32 v65, v65
    s_nop 0
    v_cvt_pk_bf16_f32 v69, v65, v65
    v_and_b32 v67, 0xffff0000, v69
    s_nop 0
    v_and_b32_dpp v72, v69, v12 row_newbcast:0 row_mask:0xf bank_mask:0xf
    v_and_b32_dpp v73, v69, v13 row_newbcast:0 row_mask:0xf bank_mask:0xf
    v_and_b32_dpp v74, v69, v14 row_newbcast:0 row_mask:0xf bank_mask:0xf
    v_and_b32_dpp v75, v69, v15 row_newbcast:0 row_mask:0xf bank_mask:0xf
    v_add_f32_dpp v67, v67, v67 row_ror:8 row_mask:0xf bank_mask:0xf
    s_nop 1
    v_add_f32_dpp v67, v67, v67 row_ror:4 row_mask:0xf bank_mask:0xf
    s_nop 1
    v_add_f32_dpp v67, v67, v67 row_ror:2 row_mask:0xf bank_mask:0xf
    s_nop 1
    v_add_f32_dpp v67, v67, v67 row_ror:1 row_mask:0xf bank_mask:0xf
    v_mov_b32 v4, v67
    s_nop 1
    v_permlane16_swap_b32 v67, v4
    v_add_f32 v67, v67, v4
    v_mov_b32 v4, v67
    s_nop 1
    v_permlane32_swap_b32 v67, v4
    v_add_f32 v67, v67, v4
    s_lshl_b32 s62, s3, 3
    v_mov_b32 v5, s62
    v_mov_b32 v6, 1
    v_mov_b32 v4, 0
    s_mov_b64 exec, 1
    ds_write_b64 v5, v[66:67] offset:320
    ds_add_u32 v4, v6 offset:8
    s_mov_b64 exec, -1
    v_and_b32_dpp v76, v69, v12 row_newbcast:4 row_mask:0xf bank_mask:0xf
    v_and_b32_dpp v77, v69, v13 row_newbcast:4 row_mask:0xf bank_mask:0xf
    v_and_b32_dpp v78, v69, v14 row_newbcast:4 row_mask:0xf bank_mask:0xf
    v_and_b32_dpp v79, v69, v15 row_newbcast:4 row_mask:0xf bank_mask:0xf
    s_waitcnt vmcnt(15)
    v_mfma_f32_16x16x32_bf16 v[80:83], v[72:75], v[160:163], 0
    v_and_b32_dpp v72, v69, v12 row_newbcast:8 row_mask:0xf bank_mask:0xf
    v_and_b32_dpp v73, v69, v13 row_newbcast:8 row_mask:0xf bank_mask:0xf
    v_and_b32_dpp v74, v69, v14 row_newbcast:8 row_mask:0xf bank_mask:0xf
    v_and_b32_dpp v75, v69, v15 row_newbcast:8 row_mask:0xf bank_mask:0xf
    s_waitcnt vmcnt(14)
    v_mfma_f32_16x16x32_bf16 v[80:83], v[76:79], v[164:167], v[80:83]
    v_and_b32_dpp v76, v69, v12 row_newbcast:12 row_mask:0xf bank_mask:0xf
    v_and_b32_dpp v77, v69, v13 row_newbcast:12 row_mask:0xf bank_mask:0xf
    v_and_b32_dpp v78, v69, v14 row_newbcast:12 row_mask:0xf bank_mask:0xf
    v_and_b32_dpp v79, v69, v15 row_newbcast:12 row_mask:0xf bank_mask:0xf
    s_waitcnt vmcnt(13)
    v_mfma_f32_16x16x32_bf16 v[80:83], v[72:75], v[168:171], v[80:83]
    v_and_b32_dpp v72, v69, v12 row_newbcast:1 row_mask:0xf bank_mask:0xf
    v_and_b32_dpp v73, v69, v13 row_newbcast:1 row_mask:0xf bank_mask:0xf
    v_and_b32_dpp v74, v69, v14 row_newbcast:1 row_mask:0xf bank_mask:0xf
    v_and_b32_dpp v75, v69, v15 row_newbcast:1 row_mask:0xf bank_mask:0xf
    s_waitcnt vmcnt(12)
    v_mfma_f32_16x16x32_bf16 v[80:83], v[76:79], v[172:175], v[80:83]
    v_and_b32_dpp v76, v69, v12 row_newbcast:5 row_mask:0xf bank_mask:0xf
    v_and_b32_dpp v77, v69, v13 row_newbcast:5 row_mask:0xf bank_mask:0xf
    v_and_b32_dpp v78, v69, v14 row_newbcast:5 row_mask:0xf bank_mask:0xf
    v_and_b32_dpp v79, v69, v15 row_newbcast:5 row_mask:0xf bank_mask:0xf
    s_waitcnt vmcnt(11)
    v_mfma_f32_16x16x32_bf16 v[80:83], v[72:75], v[176:179], v[80:83]
    v_and_b32_dpp v72, v69, v12 row_newbcast:9 row_mask:0xf bank_mask:0xf
    v_and_b32_dpp v73, v69, v13 row_newbcast:9 row_mask:0xf bank_mask:0xf
    v_and_b32_dpp v74, v69, v14 row_newbcast:9 row_mask:0xf bank_mask:0xf
    v_and_b32_dpp v75, v69, v15 row_newbcast:9 row_mask:0xf bank_mask:0xf
    s_waitcnt vmcnt(10)
    v_mfma_f32_16x16x32_bf16 v[80:83], v[76:79], v[180:183], v[80:83]
    v_and_b32_dpp v76, v69, v12 row_newbcast:13 row_mask:0xf bank_mask:0xf
    v_and_b32_dpp v77, v69, v13 row_newbcast:13 row_mask:0xf bank_mask:0xf
    v_and_b32_dpp v78, v69, v14 row_newbcast:13 row_mask:0xf bank_mask:0xf
    v_and_b32_dpp v79, v69, v15 row_newbcast:13 row_mask:0xf bank_mask:0xf
    s_waitcnt vmcnt(9)
    v_mfma_f32_16x16x32_bf16 v[80:83], v[72:75], v[184:187], v[80:83]
    v_and_b32_dpp v72, v69, v12 row_newbcast:2 row_mask:0xf bank_mask:0xf
    v_and_b32_dpp v73, v69, v13 row_newbcast:2 row_mask:0xf bank_mask:0xf
    v_and_b32_dpp v74, v69, v14 row_newbcast:2 row_mask:0xf bank_mask:0xf
    v_and_b32_dpp v75, v69, v15 row_newbcast:2 row_mask:0xf bank_mask:0xf
    s_waitcnt vmcnt(8)
    v_mfma_f32_16x16x32_bf16 v[80:83], v[76:79], v[188:191], v[80:83]
    v_and_b32_dpp v76, v69, v12 row_newbcast:6 row_mask:0xf bank_mask:0xf
    v_and_b32_dpp v77, v69, v13 row_newbcast:6 row_mask:0xf bank_mask:0xf
    v_and_b32_dpp v78, v69, v14 row_newbcast:6 row_mask:0xf bank_mask:0xf
    v_and_b32_dpp v79, v69, v15 row_newbcast:6 row_mask:0xf bank_mask:0xf
    s_waitcnt vmcnt(7)
    v_mfma_f32_16x16x32_bf16 v[80:83], v[72:75], v[192:195], v[80:83]
    v_and_b32_dpp v72, v69, v12 row_newbcast:10 row_mask:0xf bank_mask:0xf
    v_and_b32_dpp v73, v69, v13 row_newbcast:10 row_mask:0xf bank_mask:0xf
    v_and_b32_dpp v74, v69, v14 row_newbcast:10 row_mask:0xf bank_mask:0xf
    v_and_b32_dpp v75, v69, v15 row_newbcast:10 row_mask:0xf bank_mask:0xf
    s_waitcnt vmcnt(6)
    v_mfma_f32_16x16x32_bf16 v[80:83], v[76:79], v[196:199], v[80:83]
    s_cmp_lg_u32 s3, 0
    s_cbranch_scc1 Lf_8
    v_mov_b32 v4, 0
    s_mov_b32 s11, 320000
Lmllp_9:
    ds_read_b32 v16, v4 offset:8
    s_waitcnt lgkmcnt(0)
    v_readfirstlane_b32 s62, v16
    s_nop 0
    s_cmp_eq_u32 s62, 8
    s_cbranch_scc1 Lmldn_10
    s_sub_u32 s11, s11, 1
    s_cmp_lg_u32 s11, 0
    s_cbranch_scc1 Lmllp_9
Lmldn_10:
    v_and_b32 v4, 7, v1
    v_lshlrev_b32 v4, 3, v4
    ds_read_b64 v[16:17], v4 offset:320
    s_waitcnt lgkmcnt(0)
    v_mov_b32 v18, v16
    s_nop 1
    v_max_f32_dpp v18, v18, v18 row_ror:4 row_mask:0xf bank_mask:0xf
    s_nop 1
    v_max_f32_dpp v18, v18, v18 row_ror:2 row_mask:0xf bank_mask:0xf
    s_nop 1
    v_max_f32_dpp v18, v18, v18 row_ror:1 row_mask:0xf bank_mask:0xf
    v_sub_f32 v16, v16, v18
    v_exp_f32 v16, v16
    s_nop 0
    v_mul_f32 v19, v17, v16
    s_nop 1
    v_add_f32_dpp v19, v19, v19 row_ror:4 row_mask:0xf bank_mask:0xf
    s_nop 1
    v_add_f32_dpp v19, v19, v19 row_ror:2 row_mask:0xf bank_mask:0xf
    s_nop 1
    v_add_f32_dpp v19, v19, v19 row_ror:1 row_mask:0xf bank_mask:0xf
    v_rcp_f32 v4, v19
    v_mov_b32 v44, v18
    v_mov_b32 v45, s8
    v_mov_b32 v46, v19
    v_mov_b32 v47, s8
    v_mul_f32 v16, v16, v4
Lf_8:
    s_nop 1
    v_and_b32_dpp v76, v69, v12 row_newbcast:14 row_mask:0xf bank_mask:0xf
    v_and_b32_dpp v77, v69, v13 row_newbcast:14 row_mask:0xf bank_mask:0xf
    v_and_b32_dpp v78, v69, v14 row_newbcast:14 row_mask:0xf bank_mask:0xf
    v_and_b32_dpp v79, v69, v15 row_newbcast:14 row_mask:0xf bank_mask:0xf
    s_waitcnt vmcnt(5)
    v_mfma_f32_16x16x32_bf16 v[80:83], v[72:75], v[200:203], v[80:83]
    v_and_b32_dpp v72, v69, v12 row_newbcast:3 row_mask:0xf bank_mask:0xf
    v_and_b32_dpp v73, v69, v13 row_newbcast:3 row_mask:0xf bank_mask:0xf
    v_and_b32_dpp v74, v69, v14 row_newbcast:3 row_mask:0xf bank_mask:0xf
    v_and_b32_dpp v75, v69, v15 row_newbcast:3 row_mask:0xf bank_mask:0xf
    s_waitcnt vmcnt(4)
    v_mfma_f32_16x16x32_bf16 v[80:83], v[76:79], v[204:207], v[80:83]
    v_and_b32_dpp v76, v69, v12 row_newbcast:7 row_mask:0xf bank_mask:0xf
    v_and_b32_dpp v77, v69, v13 row_newbcast:7 row_mask:0xf bank_mask:0xf
    v_and_b32_dpp v78, v69, v14 row_newbcast:7 row_mask:0xf bank_mask:0xf
    v_and_b32_dpp v79, v69, v15 row_newbcast:7 row_mask:0xf bank_mask:0xf
    s_waitcnt vmcnt(3)
    v_mfma_f32_16x16x32_bf16 v[80:83], v[72:75], v[208:211], v[80:83]
    v_and_b32_dpp v72, v69, v12 row_newbcast:11 row_mask:0xf bank_mask:0xf
    v_and_b32_dpp v73, v69, v13 row_newbcast:11 row_mask:0xf bank_mask:0xf
    v_and_b32_dpp v74, v69, v14 row_newbcast:11 row_mask:0xf bank_mask:0xf
    v_and_b32_dpp v75, v69, v15 row_newbcast:11 row_mask:0xf bank_mask:0xf
    s_waitcnt vmcnt(2)
    v_mfma_f32_16x16x32_bf16 v[80:83], v[76:79], v[212:215], v[80:83]
    v_and_b32_dpp v76, v69, v12 row_newbcast:15 row_mask:0xf bank_mask:0xf
    v_and_b32_dpp v77, v69, v13 row_newbcast:15 row_mask:0xf bank_mask:0xf
    v_and_b32_dpp v78, v69, v14 row_newbcast:15 row_mask:0xf bank_mask:0xf
    v_and_b32_dpp v79, v69, v15 row_newbcast:15 row_mask:0xf bank_mask:0xf
    s_waitcnt vmcnt(1)
    v_mfma_f32_16x16x32_bf16 v[80:83], v[72:75], v[216:219], v[80:83]
    s_waitcnt vmcnt(0)
    v_mfma_f32_16x16x32_bf16 v[80:83], v[76:79], v[220:223], v[80:83]
    s_cmp_eq_u32 s3, 0
    s_cbranch_scc1 Lwe_11
    v_and_b32 v5, 1, v10
    v_lshlrev_b32 v5, 1, v5
    v_and_b32 v6, 7, v1
    v_xor_b32 v5, v5, v6
    v_lshlrev_b32 v5, 4, v5
    v_lshrrev_b32 v6, 3, v1
    v_lshl_add_u32 v226, v6, 10, v5
    v_xor_b32 v227, 64, v226
    s_lshl_b32 s62, s4, 17
    s_lshl_b32 s63, s7, 7
    s_add_u32 s62, s62, s63
    s_add_u32 s16, s24, s62
    s_addc_u32 s17, s25, 0
    s_mov_b32 s18, 130176
    s_mov_b32 s19, 0x20000
    v_mov_b32 v4, 0
    s_mov_b32 s11, 320000
Lcvlp_14:
    ds_read_b32 v16, v4 offset:12
    s_waitcnt lgkmcnt(0)
    v_readfirstlane_b32 s62, v16
    s_nop 0
    s_cmp_eq_u32 s62, 4
    s_cbranch_scc1 Lcvdn_15
    s_sub_u32 s11, s11, 1
    s_cmp_lg_u32 s11, 0
    s_cbranch_scc1 Lcvlp_14
Lcvdn_15:
    s_cmp_eq_u32 s3, 2
    s_cbranch_scc1 Lw2_12
    s_cmp_eq_u32 s3, 3
    s_cbranch_scc1 Lw3_13
    s_mov_b32 m0, 8192
    s_mov_b32 s62, 0
    buffer_load_dwordx4 v226, s[16:19], s62 offen nt lds
    s_mov_b32 m0, 9216
    s_mov_b32 s62, 8192
    buffer_load_dwordx4 v227, s[16:19], s62 offen nt lds
    s_mov_b32 m0, 10240
    s_mov_b32 s62, 16384
    buffer_load_dwordx4 v226, s[16:19], s62 offen nt lds
    s_mov_b32 m0, 11264
    s_mov_b32 s62, 24576
    buffer_load_dwordx4 v227, s[16:19], s62 offen nt lds
    s_mov_b32 m0, 12288
    s_mov_b32 s62, 32768
    buffer_load_dwordx4 v226, s[16:19], s62 offen nt lds
    s_mov_b32 m0, 13312
    s_mov_b32 s62, 40960
    buffer_load_dwordx4 v227, s[16:19], s62 offen nt lds
    s_branch Lwe_11
Lw2_12:
    s_mov_b32 m0, 14336
    s_mov_b32 s62, 49152
    buffer_load_dwordx4 v226, s[16:19], s62 offen nt lds
    s_mov_b32 m0, 15360
    s_mov_b32 s62, 57344
    buffer_load_dwordx4 v227, s[16:19], s62 offen nt lds
    s_mov_b32 m0, 16384
    s_mov_b32 s62, 65536
    buffer_load_dwordx4 v226, s[16:19], s62 offen nt lds
    s_mov_b32 m0, 17408
    s_mov_b32 s62, 73728
    buffer_load_dwordx4 v227, s[16:19], s62 offen nt lds
    s_mov_b32 m0, 18432
    s_mov_b32 s62, 81920
    buffer_load_dwordx4 v226, s[16:19], s62 offen nt lds
    s_branch Lwe_11
Lw3_13:
    s_mov_b32 m0, 19456
    s_mov_b32 s62, 90112
    buffer_load_dwordx4 v227, s[16:19], s62 offen nt lds
    s_mov_b32 m0, 20480
    s_mov_b32 s62, 98304
    buffer_load_dwordx4 v226, s[16:19], s62 offen nt lds
    s_mov_b32 m0, 21504
    s_mov_b32 s62, 106496
    buffer_load_dwordx4 v227, s[16:19], s62 offen nt lds
    s_mov_b32 m0, 22528
    s_mov_b32 s62, 114688
    buffer_load_dwordx4 v226, s[16:19], s62 offen nt lds
    s_mov_b32 m0, 23552
    s_mov_b32 s62, 122880
    buffer_load_dwordx4 v227, s[16:19], s62 offen nt lds
Lwe_11:
    v_lshlrev_b32 v4, 5, v11
    v_lshl_add_u32 v4, v10, 4, v4
    s_lshl_b32 s62, s3, 9
    v_add_u32 v4, s62, v4
    s_mov_b32 exec_hi, 0
    ds_write_b128 v4, v[80:83] offset:512
    s_mov_b32 exec_hi, -1
    s_waitcnt lgkmcnt(0)
    s_barrier
    s_cmp_lg_u32 s3, 0
    s_cbranch_scc1 Lm_16
    v_lshlrev_b32 v5, 3, v1
    ds_read_b64 v[20:21], v5 offset:512
    ds_read_b64 v[22:23], v5 offset:1024
    ds_read_b64 v[24:25], v5 offset:1536
    ds_read_b64 v[26:27], v5 offset:2048
    ds_read_b64 v[28:29], v5 offset:2560
    ds_read_b64 v[30:31], v5 offset:3072
    ds_read_b64 v[32:33], v5 offset:3584
    ds_read_b64 v[34:35], v5 offset:4096
    s_lshl_b32 s62, s4, 12
    s_lshl_b32 s63, s7, 9
    s_add_u32 s62, s62, s63
    s_add_u32 s62, s62, 393216
    s_lshl_b32 s63, s4, 7
    s_lshl_b32 s12, s7, 4
    s_add_u32 s63, s63, s12
    s_add_u32 s63, s63, 524288
    v_mov_b32 v39, s8
    v_mov_b32 v4, 0
    s_waitcnt lgkmcnt(0)
    v_mul_f32_dpp v36, v16, v20 row_newbcast:0 row_mask:0xf bank_mask:0xf
    v_mul_f32_dpp v37, v16, v21 row_newbcast:0 row_mask:0xf bank_mask:0xf
    v_mul_f32_dpp v40, v16, v22 row_newbcast:1 row_mask:0xf bank_mask:0xf
    v_mul_f32_dpp v41, v16, v23 row_newbcast:1 row_mask:0xf bank_mask:0xf
    v_fmac_f32_dpp v36, v16, v24 row_newbcast:2 row_mask:0xf bank_mask:0xf
    v_fmac_f32_dpp v37, v16, v25 row_newbcast:2 row_mask:0xf bank_mask:0xf
    v_fmac_f32_dpp v40, v16, v26 row_newbcast:3 row_mask:0xf bank_mask:0xf
    v_fmac_f32_dpp v41, v16, v27 row_newbcast:3 row_mask:0xf bank_mask:0xf
    v_fmac_f32_dpp v36, v16, v28 row_newbcast:4 row_mask:0xf bank_mask:0xf
    v_fmac_f32_dpp v37, v16, v29 row_newbcast:4 row_mask:0xf bank_mask:0xf
    v_fmac_f32_dpp v40, v16, v30 row_newbcast:5 row_mask:0xf bank_mask:0xf
    v_fmac_f32_dpp v41, v16, v31 row_newbcast:5 row_mask:0xf bank_mask:0xf
    v_fmac_f32_dpp v36, v16, v32 row_newbcast:6 row_mask:0xf bank_mask:0xf
    v_fmac_f32_dpp v37, v16, v33 row_newbcast:6 row_mask:0xf bank_mask:0xf
    v_fmac_f32_dpp v40, v16, v34 row_newbcast:7 row_mask:0xf bank_mask:0xf
    v_fmac_f32_dpp v41, v16, v35 row_newbcast:7 row_mask:0xf bank_mask:0xf
    v_add_f32 v36, v36, v40
    v_add_f32 v37, v37, v41
    v_cvt_pk_bf16_f32 v38, v36, v37
    s_cmp_eq_u32 s79, 0
    s_cbranch_scc1 Lm_16s
    buffer_store_dwordx2 v[38:39], v5, s[48:51], s62 offen
    s_mov_b64 exec, 1
    buffer_store_dwordx4 v[44:47], v4, s[48:51], s63 offen
    s_mov_b64 exec, -1
    s_branch Lm_16
Lm_16s:
    buffer_store_dwordx2 v[38:39], v5, s[48:51], s62 offen sc1
    s_mov_b64 exec, 1
    buffer_store_dwordx4 v[44:47], v4, s[48:51], s63 offen sc1
    s_mov_b64 exec, -1
Lm_16:
    s_nop 1
    v_and_b32 v4, 7, v11
    v_lshrrev_b32 v6, 3, v11
    v_lshlrev_b32 v5, 9, v4
    v_lshl_add_u32 v5, v6, 4, v5
    v_lshl_add_u32 v5, v10, 5, v5
    v_lshlrev_b32 v7, 4, v4
    s_lshl_b32 s62, s4, 12
    s_lshl_b32 s63, s3, 7
    s_add_u32 s62, s62, s63
    s_add_u32 s62, s62, 393216
    s_lshl_b32 s63, s4, 7
    s_add_u32 s63, s63, 524288
    buffer_load_dwordx4 v[20:23], v5, s[48:51], s62 offen sc1
    buffer_load_dwordx4 v[24:27], v7, s[48:51], s63 offen sc1
    v_mul_u32_u24 v8, 272, v4
    v_lshl_add_u32 v9, v10, 4, v8
    v_lshl_add_u32 v8, v6, 3, v9
    s_lshl_b32 s12, s3, 6
    v_add_u32 v8, s12, v8
    v_lshrrev_b32 v6, 2, v11
    v_lshl_add_u32 v28, v10, 3, v6
    v_lshlrev_b32 v28, 7, v28
    v_lshrrev_b32 v29, 1, v6
    v_and_b32 v30, 1, v10
    v_lshl_add_u32 v29, v30, 1, v29
    v_xor_b32 v29, s3, v29
    v_lshl_add_u32 v28, v29, 5, v28
    v_and_b32 v29, 3, v1
    v_lshl_add_u32 v28, v29, 3, v28
    v_lshlrev_b32 v29, 4, v29
    v_lshl_add_u32 v29, v10, 6, v29
    s_lshl_b32 s13, s7, 2
    s_add_u32 s13, s13, s3
    s_lshl_b32 s13, s13, 13
    s_lshl_b32 s14, s4, 8
    s_add_u32 s13, s13, s14
    s_add_u32 s13, s13, 131072
    s_waitcnt vmcnt(0)
    v_cmpx_eq_u32 vcc, s8, v21
    v_cmpx_eq_u32 vcc, s8, v23
    v_cmpx_eq_u32 vcc, s8, v25
    v_cmpx_eq_u32 vcc, s8, v27
    s_nop 0
    s_cmp_eq_u64 exec, -1
    s_mov_b64 exec, -1
    s_cbranch_scc1 Look_17
    s_mov_b32 s11, 40000
Olp_18:
    s_nop 1
    buffer_load_dwordx4 v[20:23], v5, s[48:51], s62 offen sc1
    buffer_load_dwordx4 v[24:27], v7, s[48:51], s63 offen sc1
    s_waitcnt vmcnt(0)
    v_cmpx_eq_u32 vcc, s8, v21
    v_cmpx_eq_u32 vcc, s8, v23
    v_cmpx_eq_u32 vcc, s8, v25
    v_cmpx_eq_u32 vcc, s8, v27
    s_nop 0
    s_cmp_eq_u64 exec, -1
    s_mov_b64 exec, -1
    s_cbranch_scc1 Odn_19
    s_sub_u32 s11, s11, 1
    s_cmp_lg_u32 s11, 0
    s_cbranch_scc1 Olp_18
Odn_19:
    s_nop 1
Look_17:
    s_nop 1
    v_add_u32 v8, 4608, v8
    ds_write2_b32 v8, v20, v22 offset0:0 offset1:1
    v_max_f32_dpp v74, v24, v24 row_ror:4 row_mask:0xf bank_mask:0xf
    v_sub_f32 v74, v24, v74
    v_exp_f32 v74, v74
    s_nop 0
    v_mul_f32 v74, v74, v26
    s_nop 1
    v_add_f32_dpp v75, v74, v74 row_ror:4 row_mask:0xf bank_mask:0xf
    v_rcp_f32 v75, v75
    s_nop 0
    v_mul_f32 v74, v74, v75
    s_waitcnt lgkmcnt(0)
    s_barrier
    ds_read_b128 v[52:55], v9 offset:4608
    ds_read_b64_tr_b16 v[36:37], v28 offset:8192
    ds_read_b64_tr_b16 v[38:39], v28 offset:8704
    ds_read_b128 v[56:59], v9 offset:4672
    ds_read_b64_tr_b16 v[40:41], v28 offset:12288
    ds_read_b64_tr_b16 v[42:43], v28 offset:12800
    ds_read_b128 v[60:63], v9 offset:4736
    ds_read_b64_tr_b16 v[44:45], v28 offset:16384
    ds_read_b64_tr_b16 v[46:47], v28 offset:16896
    ds_read_b128 v[64:67], v9 offset:4800
    ds_read_b64_tr_b16 v[48:49], v28 offset:20480
    ds_read_b64_tr_b16 v[50:51], v28 offset:20992
    s_waitcnt lgkmcnt(9)
    v_mfma_f32_16x16x32_bf16 v[68:71], v[36:39], v[52:55], 0
    s_waitcnt lgkmcnt(6)
    v_mfma_f32_16x16x32_bf16 v[68:71], v[40:43], v[56:59], v[68:71]
    s_waitcnt lgkmcnt(3)
    v_mfma_f32_16x16x32_bf16 v[68:71], v[44:47], v[60:63], v[68:71]
    s_waitcnt lgkmcnt(0)
    v_mfma_f32_16x16x32_bf16 v[68:71], v[48:51], v[64:67], v[68:71]
    s_nop 7
    v_mul_f32 v68, v68, v74
    v_mul_f32 v69, v69, v74
    v_mul_f32 v70, v70, v74
    v_mul_f32 v71, v71, v74
    v_add_f32_dpp v68, v68, v68 row_ror:4 row_mask:0xf bank_mask:0xf
    v_add_f32_dpp v69, v69, v69 row_ror:4 row_mask:0xf bank_mask:0xf
    v_add_f32_dpp v70, v70, v70 row_ror:4 row_mask:0xf bank_mask:0xf
    v_add_f32_dpp v71, v71, v71 row_ror:4 row_mask:0xf bank_mask:0xf
    v_bfi_b32 v72, s61, v232, v68
    v_bfi_b32 v73, s61, v233, v69
    v_bfi_b32 v74, s61, v234, v70
    v_bfi_b32 v75, s61, v235, v71
    s_mov_b32 s14, 0x000f000f
    s_mov_b32 s15, 0x000f000f
    s_mov_b64 exec, s[14:15]
    buffer_store_dwordx4 v[72:75], v29, s[48:51], s13 offen sc1
    s_mov_b64 exec, -1
    s_cmp_eq_u32 s26, 0
    s_cbranch_scc1 L_done
    s_barrier
    v_lshrrev_b32 v6, 2, v11
    v_and_b32 v7, 3, v1
    v_lshlrev_b32 v7, 3, v7
    s_lshl_b32 s62, s3, 8
    s_add_u32 s62, s62, 57344
    v_add_u32 v7, s62, v7
    v_mul_u32_u24 v8, 4224, v10
    v_add_u32 v7, v7, v8
    v_sub_u32 v8, 0, v6
    v_and_b32 v8, 3, v8
    v_mul_u32_u24 v8, 1056, v8
    v_add_u32 v84, v7, v8
    v_sub_u32 v8, 1, v6
    v_and_b32 v8, 3, v8
    v_mul_u32_u24 v8, 1056, v8
    v_add_u32 v85, v7, v8
    v_sub_u32 v8, 2, v6
    v_and_b32 v8, 3, v8
    v_mul_u32_u24 v8, 1056, v8
    v_add_u32 v86, v7, v8
    v_sub_u32 v8, 3, v6
    v_and_b32 v8, 3, v8
    v_mul_u32_u24 v8, 1056, v8
    v_add_u32 v87, v7, v8
    s_lshl_b32 s15, s3, 12
    v_lshl_add_u32 v5, v1, 3, s15
    v_lshrrev_b32 v9, 2, v1
    v_lshlrev_b32 v9, 2, v9
    s_barrier
    ds_read_b64_tr_b16 v[32:33], v5 offset:24576
    ds_read_b64_tr_b16 v[48:49], v5 offset:40960
    ds_read_b64_tr_b16 v[34:35], v5 offset:25088
    ds_read_b64_tr_b16 v[50:51], v5 offset:41472
    ds_read_b64_tr_b16 v[36:37], v5 offset:25600
    ds_read_b64_tr_b16 v[52:53], v5 offset:41984
    ds_read_b64_tr_b16 v[38:39], v5 offset:26112
    ds_read_b64_tr_b16 v[54:55], v5 offset:42496
    ds_read_b64_tr_b16 v[40:41], v5 offset:26624
    ds_read_b64_tr_b16 v[56:57], v5 offset:43008
    ds_read_b64_tr_b16 v[42:43], v5 offset:27136
    ds_read_b64_tr_b16 v[58:59], v5 offset:43520
    ds_read_b64_tr_b16 v[44:45], v5 offset:27648
    ds_read_b64_tr_b16 v[60:61], v5 offset:44032
    ds_read_b64_tr_b16 v[46:47], v5 offset:28160
    ds_read_b64_tr_b16 v[62:63], v5 offset:44544
    ds_read_b64_tr_b16 v[16:17], v84 offset:0
    ds_read_b64_tr_b16 v[24:25], v84 offset:128
    ds_read_b64_tr_b16 v[18:19], v85 offset:32
    ds_read_b64_tr_b16 v[26:27], v85 offset:160
    ds_read_b64_tr_b16 v[20:21], v86 offset:64
    ds_read_b64_tr_b16 v[28:29], v86 offset:192
    ds_read_b64_tr_b16 v[22:23], v87 offset:96
    ds_read_b64_tr_b16 v[30:31], v87 offset:224
    ds_read_b32 v76, v9 offset:6784
    ds_read_b32 v80, v9 offset:6848
    ds_read_b32 v77, v9 offset:6912
    ds_read_b32 v81, v9 offset:6976
    ds_read_b32 v78, v9 offset:7040
    ds_read_b32 v82, v9 offset:7104
    ds_read_b32 v79, v9 offset:7168
    ds_read_b32 v83, v9 offset:7232
    v_and_b32 v8, 3, v1
    v_lshlrev_b32 v7, 4, v8
    v_lshl_add_u32 v7, v6, 9, v7
    v_lshl_add_u32 v7, v10, 7, v7
    s_and_b32 s62, s10, 1
    s_and_b32 s63, s9, 6
    s_add_u32 s62, s62, s63
    s_lshl_b32 s62, s62, 13
    s_lshl_b32 s63, s3, 11
    s_add_u32 s62, s62, s63
    s_add_u32 s62, s62, 65536
    s_mov_b32 s15, 5632
    v_mul_u32_u24 v92, 22528, v6
    v_mad_u32_u24 v92, v10, s15, v92
    v_lshl_add_u32 v92, v8, 4, v92
    s_mul_i32 s14, s3, 180224
    s_lshl_b32 s15, s27, 6
    s_add_u32 s14, s14, s15
    s_add_u32 s14, s14, 1114112
    s_add_u32 s15, s14, 90112
    v_lshl_add_u32 v6, v8, 6, v9
    v_lshlrev_b32 v4, 6, v11
    v_lshl_add_u32 v4, v10, 4, v4
    s_lshl_b32 s63, s3, 9
    v_add_u32 v4, s63, v4
    s_lshl_b32 s63, s3, 5
    v_lshl_add_u32 v5, v8, 3, s63
    v_lshlrev_b32 v8, 3, v8
    v_and_b32 v93, 1, v10
    v_lshl_add_u32 v5, v93, 2, v5
    s_waitcnt lgkmcnt(0)
    v_add_f32 v76, v76, v77
    v_add_f32 v78, v78, v79
    v_add_f32 v80, v80, v81
    v_add_f32 v82, v82, v83
    v_add_f32 v76, v76, v78
    v_add_f32 v80, v80, v82
    s_mov_b32 s11, 40000
Hlp_20:
    s_nop 1
    buffer_load_dwordx4 v[84:87], v7, s[48:51], s62 offen sc1
    buffer_load_dwordx4 v[88:91], v7, s[48:51], s62 offen offset:64 sc1
    s_waitcnt vmcnt(0)
    v_cmpx_eq_u32 vcc, s8, v85
    v_cmpx_eq_u32 vcc, s8, v87
    v_cmpx_eq_u32 vcc, s8, v89
    v_cmpx_eq_u32 vcc, s8, v91
    s_nop 0
    s_cmp_eq_u64 exec, -1
    s_mov_b64 exec, -1
    s_cbranch_scc1 Hdn_21
    s_sub_u32 s11, s11, 1
    s_cmp_lg_u32 s11, 0
    s_cbranch_scc1 Hlp_20
Hdn_21:
    s_nop 1
    v_cndmask_b32 v120, 0, v84, s[64:65]
    v_cndmask_b32 v121, 0, v86, s[64:65]
    v_cndmask_b32 v122, 0, v88, s[64:65]
    v_cndmask_b32 v123, 0, v90, s[64:65]
    s_nop 1
    v_mfma_f32_16x16x32_bf16 v[64:67], v[32:35], v[120:123], 0
    v_mfma_f32_16x16x32_bf16 v[68:71], v[48:51], v[120:123], 0
    v_cndmask_b32 v124, 0, v84, s[66:67]
    v_cndmask_b32 v125, 0, v86, s[66:67]
    v_cndmask_b32 v126, 0, v88, s[66:67]
    v_cndmask_b32 v127, 0, v90, s[66:67]
    s_nop 1
    v_mfma_f32_16x16x32_bf16 v[64:67], v[36:39], v[124:127], v[64:67]
    v_mfma_f32_16x16x32_bf16 v[68:71], v[52:55], v[124:127], v[68:71]
    v_cndmask_b32 v128, 0, v84, s[68:69]
    v_cndmask_b32 v129, 0, v86, s[68:69]
    v_cndmask_b32 v130, 0, v88, s[68:69]
    v_cndmask_b32 v131, 0, v90, s[68:69]
    s_nop 1
    v_mfma_f32_16x16x32_bf16 v[64:67], v[40:43], v[128:131], v[64:67]
    v_mfma_f32_16x16x32_bf16 v[68:71], v[56:59], v[128:131], v[68:71]
    v_cndmask_b32 v132, 0, v84, s[70:71]
    v_cndmask_b32 v133, 0, v86, s[70:71]
    v_cndmask_b32 v134, 0, v88, s[70:71]
    v_cndmask_b32 v135, 0, v90, s[70:71]
    s_nop 1
    v_mfma_f32_16x16x32_bf16 v[64:67], v[44:47], v[132:135], v[64:67]
    v_mfma_f32_16x16x32_bf16 v[68:71], v[60:63], v[132:135], v[68:71]
    v_dot2_f32_bf16 v96, v84, s78, 0
    v_dot2_f32_bf16 v97, v84, v84, 0
    v_dot2_f32_bf16 v98, v86, s78, 0
    v_dot2_f32_bf16 v99, v86, v86, 0
    v_dot2_f32_bf16 v96, v88, s78, v96
    v_dot2_f32_bf16 v97, v88, v88, v97
    v_dot2_f32_bf16 v98, v90, s78, v98
    v_dot2_f32_bf16 v99, v90, v90, v99
    s_nop 1
    v_add_f32 v96, v96, v98
    v_add_f32 v97, v97, v99
    s_nop 0
    v_add_f32_dpp v96, v96, v96 row_ror:4 row_mask:0xf bank_mask:0xf
    v_add_f32_dpp v97, v97, v97 row_ror:4 row_mask:0xf bank_mask:0xf
    s_nop 0
    v_add_f32_dpp v96, v96, v96 row_ror:8 row_mask:0xf bank_mask:0xf
    v_add_f32_dpp v97, v97, v97 row_ror:8 row_mask:0xf bank_mask:0xf
    s_nop 1
    v_permlane16_swap_b32 v96, v97
    v_add_f32 v96, v96, v97
    v_mov_b32 v98, v96
    s_nop 1
    v_permlane32_swap_b32 v96, v98
    v_add_f32 v96, v96, v98
    s_mov_b64 exec, 0xf000f
    ds_write_b32 v5, v96 offset:6656
    s_mov_b64 exec, -1
    v_add_f32_dpp v64, v64, v64 row_ror:4 row_mask:0xf bank_mask:0xf
    v_add_f32_dpp v65, v65, v65 row_ror:4 row_mask:0xf bank_mask:0xf
    v_add_f32_dpp v66, v66, v66 row_ror:4 row_mask:0xf bank_mask:0xf
    v_add_f32_dpp v67, v67, v67 row_ror:4 row_mask:0xf bank_mask:0xf
    v_add_f32_dpp v64, v64, v64 row_ror:8 row_mask:0xf bank_mask:0xf
    v_add_f32_dpp v65, v65, v65 row_ror:8 row_mask:0xf bank_mask:0xf
    v_add_f32_dpp v66, v66, v66 row_ror:8 row_mask:0xf bank_mask:0xf
    v_add_f32_dpp v67, v67, v67 row_ror:8 row_mask:0xf bank_mask:0xf
    v_add_f32_dpp v68, v68, v68 row_ror:4 row_mask:0xf bank_mask:0xf
    v_add_f32_dpp v69, v69, v69 row_ror:4 row_mask:0xf bank_mask:0xf
    v_add_f32_dpp v70, v70, v70 row_ror:4 row_mask:0xf bank_mask:0xf
    v_add_f32_dpp v71, v71, v71 row_ror:4 row_mask:0xf bank_mask:0xf
    v_add_f32_dpp v68, v68, v68 row_ror:8 row_mask:0xf bank_mask:0xf
    v_add_f32_dpp v69, v69, v69 row_ror:8 row_mask:0xf bank_mask:0xf
    v_add_f32_dpp v70, v70, v70 row_ror:8 row_mask:0xf bank_mask:0xf
    v_add_f32_dpp v71, v71, v71 row_ror:8 row_mask:0xf bank_mask:0xf
    s_mov_b64 exec, s[64:65]
    ds_write_b128 v4, v[64:67] offset:4608
    ds_write_b128 v4, v[68:71] offset:4864
    s_mov_b64 exec, -1
    s_waitcnt lgkmcnt(0)
    s_barrier
    ds_read_b64 v[84:85], v8 offset:6656
    ds_read_b64 v[86:87], v8 offset:6688
    ds_read_b64 v[88:89], v8 offset:6720
    ds_read_b64 v[90:91], v8 offset:6752
    ds_read_b32 v64, v6 offset:4608
    ds_read_b32 v68, v6 offset:4864
    ds_read_b32 v65, v6 offset:5120
    ds_read_b32 v69, v6 offset:5376
    ds_read_b32 v66, v6 offset:5632
    ds_read_b32 v70, v6 offset:5888
    ds_read_b32 v67, v6 offset:6144
    ds_read_b32 v71, v6 offset:6400
    s_waitcnt lgkmcnt(8)
    v_add_f32 v84, v84, v86
    v_add_f32 v85, v85, v87
    v_add_f32 v88, v88, v90
    v_add_f32 v89, v89, v91
    v_add_f32 v84, v84, v88
    v_add_f32 v85, v85, v89
    v_mul_f32 v84, 0x3b000000, v84
    v_mul_f32 v85, 0x3b000000, v85
    v_fma_f32 v85, -v84, v84, v85
    v_max_f32 v85, 0, v85
    v_cvt_pk_bf16_f32 v84, v84, v84
    v_and_b32 v84, 0xffff0000, v84
    v_cvt_pk_bf16_f32 v85, v85, v85
    v_and_b32 v85, 0xffff0000, v85
    v_add_f32 v85, 0x3727c5ac, v85
    v_cvt_pk_bf16_f32 v85, v85, v85
    v_and_b32 v85, 0xffff0000, v85
    v_sqrt_f32 v85, v85
    s_nop 0
    v_cvt_pk_bf16_f32 v85, v85, v85
    v_and_b32 v85, 0xffff0000, v85
    v_rcp_f32 v85, v85
    s_waitcnt lgkmcnt(0)
    v_add_f32 v64, v64, v65
    v_add_f32 v66, v66, v67
    v_add_f32 v68, v68, v69
    v_add_f32 v70, v70, v71
    v_add_f32 v64, v64, v66
    v_add_f32 v68, v68, v70
    v_fma_f32 v64, -v84, v76, v64
    v_fma_f32 v68, -v84, v80, v68
    v_mul_f32 v64, v85, v64
    v_mul_f32 v68, v85, v68
    v_cvt_pk_bf16_f32 v64, v64, v68
    v_lshlrev_b32 v68, 16, v64
    v_and_b32 v64, 0xffff0000, v64
    v_mul_f32 v64, v64, v68
    s_nop 1
    v_mov_b32_dpp v65, v64 row_ror:4 row_mask:0xf bank_mask:0xf
    v_mov_b32_dpp v66, v64 row_ror:8 row_mask:0xf bank_mask:0xf
    v_mov_b32_dpp v67, v64 row_ror:12 row_mask:0xf bank_mask:0xf
    v_cvt_pk_bf16_f32 v68, v64, v65
    v_cvt_pk_bf16_f32 v69, v66, v67
    v_cndmask_b32 v120, 0, v68, s[64:65]
    v_cndmask_b32 v121, 0, v69, s[64:65]
    s_nop 1
    v_mfma_f32_16x16x16_bf16 v[72:75], v[16:17], v[120:121], 0
    v_mfma_f32_16x16x16_bf16 v[76:79], v[24:25], v[120:121], 0
    v_cndmask_b32 v122, 0, v68, s[66:67]
    v_cndmask_b32 v123, 0, v69, s[66:67]
    s_nop 1
    v_mfma_f32_16x16x16_bf16 v[72:75], v[18:19], v[122:123], v[72:75]
    v_mfma_f32_16x16x16_bf16 v[76:79], v[26:27], v[122:123], v[76:79]
    v_cndmask_b32 v124, 0, v68, s[68:69]
    v_cndmask_b32 v125, 0, v69, s[68:69]
    s_nop 1
    v_mfma_f32_16x16x16_bf16 v[72:75], v[20:21], v[124:125], v[72:75]
    v_mfma_f32_16x16x16_bf16 v[76:79], v[28:29], v[124:125], v[76:79]
    v_cndmask_b32 v126, 0, v68, s[70:71]
    v_cndmask_b32 v127, 0, v69, s[70:71]
    s_nop 1
    v_mfma_f32_16x16x16_bf16 v[72:75], v[22:23], v[126:127], v[72:75]
    v_mfma_f32_16x16x16_bf16 v[76:79], v[30:31], v[126:127], v[76:79]
    s_nop 6
    v_bfi_b32 v100, s61, v232, v72
    v_bfi_b32 v101, s61, v233, v73
    v_bfi_b32 v102, s61, v234, v74
    v_bfi_b32 v103, s61, v235, v75
    buffer_store_dwordx4 v[100:103], v92, s[48:51], s14 offen sc1
    v_bfi_b32 v104, s61, v232, v76
    v_bfi_b32 v105, s61, v233, v77
    v_bfi_b32 v106, s61, v234, v78
    v_bfi_b32 v107, s61, v235, v79
    buffer_store_dwordx4 v[104:107], v92, s[48:51], s15 offen sc1
    s_branch L_done
L_commonB:
    s_nop 1
    v_and_b32 v4, 7, v1
    v_and_b32 v5, 1, v4
    v_lshrrev_b32 v4, 1, v4
    v_lshlrev_b32 v5, 4, v5
    v_mov_b32 v6, 0xffff
    v_lshlrev_b32 v6, v5, v6
    v_cmp_eq_u32 vcc, 0, v4
    s_nop 1
    v_cndmask_b32 v12, 0, v6, vcc
    v_cmp_eq_u32 vcc, 1, v4
    s_nop 1
    v_cndmask_b32 v13, 0, v6, vcc
    v_cmp_eq_u32 vcc, 2, v4
    s_nop 1
    v_cndmask_b32 v14, 0, v6, vcc
    v_cmp_eq_u32 vcc, 3, v4
    s_nop 1
    v_cndmask_b32 v15, 0, v6, vcc
    v_and_b32 v4, 3, v1
    v_lshl_add_u32 v9, v10, 2, v4
    v_lshlrev_b32 v9, 4, v9
    v_mov_b32 v4, 0
    s_mov_b32 s11, 320000
Lqlp_22:
    ds_read_b64 v[16:17], v4 offset:0
    s_waitcnt lgkmcnt(0)
    v_readfirstlane_b32 s62, v16
    s_nop 0
    s_cmp_eq_u32 s62, 1
    s_cbranch_scc1 Lqdn_23
    s_sub_u32 s11, s11, 1
    s_cmp_lg_u32 s11, 0
    s_cbranch_scc1 Lqlp_22
Lqdn_23:
    v_readfirstlane_b32 s8, v17
    ds_read_b128 v[20:23], v9 offset:64
    s_nop 0
    v_mov_b32 v232, s8
    s_lshr_b32 s62, s8, 8
    v_mov_b32 v233, s62
    s_lshr_b32 s62, s8, 16
    v_mov_b32 v234, s62
    s_lshr_b32 s62, s8, 24
    v_mov_b32 v235, s62
    s_waitcnt vmcnt(16) lgkmcnt(0)
    v_cndmask_b32 v24, 0, v20, s[64:65]
    v_cndmask_b32 v25, 0, v21, s[64:65]
    v_cndmask_b32 v26, 0, v22, s[64:65]
    v_cndmask_b32 v27, 0, v23, s[64:65]
    v_cndmask_b32 v28, 0, v20, s[66:67]
    v_cndmask_b32 v29, 0, v21, s[66:67]
    v_cndmask_b32 v30, 0, v22, s[66:67]
    v_cndmask_b32 v31, 0, v23, s[66:67]
    v_cndmask_b32 v32, 0, v20, s[68:69]
    v_cndmask_b32 v33, 0, v21, s[68:69]
    v_cndmask_b32 v34, 0, v22, s[68:69]
    v_cndmask_b32 v35, 0, v23, s[68:69]
    v_cndmask_b32 v36, 0, v20, s[70:71]
    v_cndmask_b32 v37, 0, v21, s[70:71]
    v_cndmask_b32 v38, 0, v22, s[70:71]
    v_cndmask_b32 v39, 0, v23, s[70:71]
    v_mfma_f32_16x16x32_bf16 v[40:43], v[24:27], v[96:99], 0
    v_mfma_f32_16x16x32_bf16 v[44:47], v[24:27], v[112:115], 0
    v_mfma_f32_16x16x32_bf16 v[48:51], v[24:27], v[128:131], 0
    v_mfma_f32_16x16x32_bf16 v[52:55], v[24:27], v[144:147], 0
    v_mfma_f32_16x16x32_bf16 v[40:43], v[28:31], v[100:103], v[40:43]
    v_mfma_f32_16x16x32_bf16 v[44:47], v[28:31], v[116:119], v[44:47]
    v_mfma_f32_16x16x32_bf16 v[48:51], v[28:31], v[132:135], v[48:51]
    v_mfma_f32_16x16x32_bf16 v[52:55], v[28:31], v[148:151], v[52:55]
    v_mfma_f32_16x16x32_bf16 v[40:43], v[32:35], v[104:107], v[40:43]
    v_mfma_f32_16x16x32_bf16 v[44:47], v[32:35], v[120:123], v[44:47]
    v_mfma_f32_16x16x32_bf16 v[48:51], v[32:35], v[136:139], v[48:51]
    v_mfma_f32_16x16x32_bf16 v[52:55], v[32:35], v[152:155], v[52:55]
    v_mfma_f32_16x16x32_bf16 v[40:43], v[36:39], v[108:111], v[40:43]
    v_mfma_f32_16x16x32_bf16 v[44:47], v[36:39], v[124:127], v[44:47]
    v_mfma_f32_16x16x32_bf16 v[48:51], v[36:39], v[140:143], v[48:51]
    v_mfma_f32_16x16x32_bf16 v[52:55], v[36:39], v[156:159], v[52:55]
    s_nop 4
    v_mov_b32_dpp v60, v40 quad_perm:[0,0,0,0] row_mask:0xf bank_mask:0xf
    v_mov_b32_dpp v61, v44 quad_perm:[0,0,0,0] row_mask:0xf bank_mask:0xf
    v_mov_b32_dpp v62, v48 quad_perm:[0,0,0,0] row_mask:0xf bank_mask:0xf
    v_mov_b32_dpp v63, v52 quad_perm:[0,0,0,0] row_mask:0xf bank_mask:0xf
    v_add_f32_dpp v60, v41, v60 quad_perm:[1,1,1,1] row_mask:0xf bank_mask:0xf
    v_add_f32_dpp v61, v45, v61 quad_perm:[1,1,1,1] row_mask:0xf bank_mask:0xf
    v_add_f32_dpp v62, v49, v62 quad_perm:[1,1,1,1] row_mask:0xf bank_mask:0xf
    v_add_f32_dpp v63, v53, v63 quad_perm:[1,1,1,1] row_mask:0xf bank_mask:0xf
    v_add_f32_dpp v60, v42, v60 quad_perm:[2,2,2,2] row_mask:0xf bank_mask:0xf
    v_add_f32_dpp v61, v46, v61 quad_perm:[2,2,2,2] row_mask:0xf bank_mask:0xf
    v_add_f32_dpp v62, v50, v62 quad_perm:[2,2,2,2] row_mask:0xf bank_mask:0xf
    v_add_f32_dpp v63, v54, v63 quad_perm:[2,2,2,2] row_mask:0xf bank_mask:0xf
    v_add_f32_dpp v60, v43, v60 quad_perm:[3,3,3,3] row_mask:0xf bank_mask:0xf
    v_add_f32_dpp v61, v47, v61 quad_perm:[3,3,3,3] row_mask:0xf bank_mask:0xf
    v_add_f32_dpp v62, v51, v62 quad_perm:[3,3,3,3] row_mask:0xf bank_mask:0xf
    v_add_f32_dpp v63, v55, v63 quad_perm:[3,3,3,3] row_mask:0xf bank_mask:0xf
    v_cndmask_b32 v65, v60, v61, s[72:73]
    v_cndmask_b32 v65, v65, v62, s[74:75]
    v_cndmask_b32 v65, v65, v63, s[76:77]
    v_cvt_pk_bf16_f32 v65, v65, v65
    v_and_b32 v65, 0xffff0000, v65
    v_mul_f32 v65, 0x3db504f3, v65
    v_cvt_pk_bf16_f32 v65, v65, v65
    v_and_b32 v65, 0xffff0000, v65
    v_mul_f32 v65, 0x3fb8aa3b, v65
    v_mov_b32 v66, v65
    s_nop 1
    v_max_f32_dpp v66, v66, v66 row_ror:8 row_mask:0xf bank_mask:0xf
    s_nop 1
    v_max_f32_dpp v66, v66, v66 row_ror:4 row_mask:0xf bank_mask:0xf
    s_nop 1
    v_max_f32_dpp v66, v66, v66 row_ror:2 row_mask:0xf bank_mask:0xf
    s_nop 1
    v_max_f32_dpp v66, v66, v66 row_ror:1 row_mask:0xf bank_mask:0xf
    v_mov_b32 v4, v66
    s_nop 1
    v_permlane16_swap_b32 v66, v4
    v_max_f32 v66, v66, v4
    v_mov_b32 v4, v66
    s_nop 1
    v_permlane32_swap_b32 v66, v4
    v_max_f32 v66, v66, v4
    v_sub_f32 v65, v65, v66
    v_exp_f32 v65, v65
    s_nop 0
    v_cvt_pk_bf16_f32 v69, v65, v65
    v_and_b32 v67, 0xffff0000, v69
    s_nop 0
    v_and_b32_dpp v72, v69, v12 row_newbcast:0 row_mask:0xf bank_mask:0xf
    v_and_b32_dpp v73, v69, v13 row_newbcast:0 row_mask:0xf bank_mask:0xf
    v_and_b32_dpp v74, v69, v14 row_newbcast:0 row_mask:0xf bank_mask:0xf
    v_and_b32_dpp v75, v69, v15 row_newbcast:0 row_mask:0xf bank_mask:0xf
    v_add_f32_dpp v67, v67, v67 row_ror:8 row_mask:0xf bank_mask:0xf
    s_nop 1
    v_add_f32_dpp v67, v67, v67 row_ror:4 row_mask:0xf bank_mask:0xf
    s_nop 1
    v_add_f32_dpp v67, v67, v67 row_ror:2 row_mask:0xf bank_mask:0xf
    s_nop 1
    v_add_f32_dpp v67, v67, v67 row_ror:1 row_mask:0xf bank_mask:0xf
    v_mov_b32 v4, v67
    s_nop 1
    v_permlane16_swap_b32 v67, v4
    v_add_f32 v67, v67, v4
    v_mov_b32 v4, v67
    s_nop 1
    v_permlane32_swap_b32 v67, v4
    v_add_f32 v67, v67, v4
    s_lshl_b32 s62, s3, 3
    v_mov_b32 v5, s62
    v_mov_b32 v6, 1
    v_mov_b32 v4, 0
    s_mov_b64 exec, 1
    ds_write_b64 v5, v[66:67] offset:320
    ds_add_u32 v4, v6 offset:8
    s_mov_b64 exec, -1
    s_sub_u32 s63, s3, 4
    s_lshl_b32 s63, s63, 14
    s_add_u32 s63, s63, 74240
    v_lshl_add_u32 v228, v1, 4, s63
    s_waitcnt vmcnt(15)
    ds_read_b128 v[160:163], v228 offset:0
    v_and_b32_dpp v76, v69, v12 row_newbcast:4 row_mask:0xf bank_mask:0xf
    v_and_b32_dpp v77, v69, v13 row_newbcast:4 row_mask:0xf bank_mask:0xf
    v_and_b32_dpp v78, v69, v14 row_newbcast:4 row_mask:0xf bank_mask:0xf
    v_and_b32_dpp v79, v69, v15 row_newbcast:4 row_mask:0xf bank_mask:0xf
    s_waitcnt vmcnt(14)
    ds_read_b128 v[164:167], v228 offset:1024
    s_waitcnt lgkmcnt(1)
    v_mfma_f32_16x16x32_bf16 v[80:83], v[72:75], v[160:163], 0
    v_and_b32_dpp v72, v69, v12 row_newbcast:8 row_mask:0xf bank_mask:0xf
    v_and_b32_dpp v73, v69, v13 row_newbcast:8 row_mask:0xf bank_mask:0xf
    v_and_b32_dpp v74, v69, v14 row_newbcast:8 row_mask:0xf bank_mask:0xf
    v_and_b32_dpp v75, v69, v15 row_newbcast:8 row_mask:0xf bank_mask:0xf
    s_waitcnt vmcnt(13)
    ds_read_b128 v[168:171], v228 offset:2048
    s_waitcnt lgkmcnt(1)
    v_mfma_f32_16x16x32_bf16 v[80:83], v[76:79], v[164:167], v[80:83]
    v_and_b32_dpp v76, v69, v12 row_newbcast:12 row_mask:0xf bank_mask:0xf
    v_and_b32_dpp v77, v69, v13 row_newbcast:12 row_mask:0xf bank_mask:0xf
    v_and_b32_dpp v78, v69, v14 row_newbcast:12 row_mask:0xf bank_mask:0xf
    v_and_b32_dpp v79, v69, v15 row_newbcast:12 row_mask:0xf bank_mask:0xf
    s_waitcnt vmcnt(12)
    ds_read_b128 v[172:175], v228 offset:3072
    s_waitcnt lgkmcnt(1)
    v_mfma_f32_16x16x32_bf16 v[80:83], v[72:75], v[168:171], v[80:83]
    v_and_b32_dpp v72, v69, v12 row_newbcast:1 row_mask:0xf bank_mask:0xf
    v_and_b32_dpp v73, v69, v13 row_newbcast:1 row_mask:0xf bank_mask:0xf
    v_and_b32_dpp v74, v69, v14 row_newbcast:1 row_mask:0xf bank_mask:0xf
    v_and_b32_dpp v75, v69, v15 row_newbcast:1 row_mask:0xf bank_mask:0xf
    s_waitcnt vmcnt(11)
    ds_read_b128 v[176:179], v228 offset:4096
    s_waitcnt lgkmcnt(1)
    v_mfma_f32_16x16x32_bf16 v[80:83], v[76:79], v[172:175], v[80:83]
    v_and_b32_dpp v76, v69, v12 row_newbcast:5 row_mask:0xf bank_mask:0xf
    v_and_b32_dpp v77, v69, v13 row_newbcast:5 row_mask:0xf bank_mask:0xf
    v_and_b32_dpp v78, v69, v14 row_newbcast:5 row_mask:0xf bank_mask:0xf
    v_and_b32_dpp v79, v69, v15 row_newbcast:5 row_mask:0xf bank_mask:0xf
    s_waitcnt vmcnt(10)
    ds_read_b128 v[180:183], v228 offset:5120
    s_waitcnt lgkmcnt(1)
    v_mfma_f32_16x16x32_bf16 v[80:83], v[72:75], v[176:179], v[80:83]
    v_and_b32_dpp v72, v69, v12 row_newbcast:9 row_mask:0xf bank_mask:0xf
    v_and_b32_dpp v73, v69, v13 row_newbcast:9 row_mask:0xf bank_mask:0xf
    v_and_b32_dpp v74, v69, v14 row_newbcast:9 row_mask:0xf bank_mask:0xf
    v_and_b32_dpp v75, v69, v15 row_newbcast:9 row_mask:0xf bank_mask:0xf
    s_waitcnt vmcnt(9)
    ds_read_b128 v[184:187], v228 offset:6144
    s_waitcnt lgkmcnt(1)
    v_mfma_f32_16x16x32_bf16 v[80:83], v[76:79], v[180:183], v[80:83]
    v_and_b32_dpp v76, v69, v12 row_newbcast:13 row_mask:0xf bank_mask:0xf
    v_and_b32_dpp v77, v69, v13 row_newbcast:13 row_mask:0xf bank_mask:0xf
    v_and_b32_dpp v78, v69, v14 row_newbcast:13 row_mask:0xf bank_mask:0xf
    v_and_b32_dpp v79, v69, v15 row_newbcast:13 row_mask:0xf bank_mask:0xf
    s_waitcnt vmcnt(8)
    ds_read_b128 v[188:191], v228 offset:7168
    s_waitcnt lgkmcnt(1)
    v_mfma_f32_16x16x32_bf16 v[80:83], v[72:75], v[184:187], v[80:83]
    v_and_b32_dpp v72, v69, v12 row_newbcast:2 row_mask:0xf bank_mask:0xf
    v_and_b32_dpp v73, v69, v13 row_newbcast:2 row_mask:0xf bank_mask:0xf
    v_and_b32_dpp v74, v69, v14 row_newbcast:2 row_mask:0xf bank_mask:0xf
    v_and_b32_dpp v75, v69, v15 row_newbcast:2 row_mask:0xf bank_mask:0xf
    s_waitcnt vmcnt(7)
    ds_read_b128 v[192:195], v228 offset:8192
    s_waitcnt lgkmcnt(1)
    v_mfma_f32_16x16x32_bf16 v[80:83], v[76:79], v[188:191], v[80:83]
    v_and_b32_dpp v76, v69, v12 row_newbcast:6 row_mask:0xf bank_mask:0xf
    v_and_b32_dpp v77, v69, v13 row_newbcast:6 row_mask:0xf bank_mask:0xf
    v_and_b32_dpp v78, v69, v14 row_newbcast:6 row_mask:0xf bank_mask:0xf
    v_and_b32_dpp v79, v69, v15 row_newbcast:6 row_mask:0xf bank_mask:0xf
    s_waitcnt vmcnt(6)
    ds_read_b128 v[196:199], v228 offset:9216
    s_waitcnt lgkmcnt(1)
    v_mfma_f32_16x16x32_bf16 v[80:83], v[72:75], v[192:195], v[80:83]
    v_and_b32_dpp v72, v69, v12 row_newbcast:10 row_mask:0xf bank_mask:0xf
    v_and_b32_dpp v73, v69, v13 row_newbcast:10 row_mask:0xf bank_mask:0xf
    v_and_b32_dpp v74, v69, v14 row_newbcast:10 row_mask:0xf bank_mask:0xf
    v_and_b32_dpp v75, v69, v15 row_newbcast:10 row_mask:0xf bank_mask:0xf
    s_waitcnt vmcnt(5)
    ds_read_b128 v[200:203], v228 offset:10240
    s_waitcnt lgkmcnt(1)
    v_mfma_f32_16x16x32_bf16 v[80:83], v[76:79], v[196:199], v[80:83]
    v_and_b32_dpp v76, v69, v12 row_newbcast:14 row_mask:0xf bank_mask:0xf
    v_and_b32_dpp v77, v69, v13 row_newbcast:14 row_mask:0xf bank_mask:0xf
    v_and_b32_dpp v78, v69, v14 row_newbcast:14 row_mask:0xf bank_mask:0xf
    v_and_b32_dpp v79, v69, v15 row_newbcast:14 row_mask:0xf bank_mask:0xf
    s_waitcnt vmcnt(4)
    ds_read_b128 v[204:207], v228 offset:11264
    s_waitcnt lgkmcnt(1)
    v_mfma_f32_16x16x32_bf16 v[80:83], v[72:75], v[200:203], v[80:83]
    v_and_b32_dpp v72, v69, v12 row_newbcast:3 row_mask:0xf bank_mask:0xf
    v_and_b32_dpp v73, v69, v13 row_newbcast:3 row_mask:0xf bank_mask:0xf
    v_and_b32_dpp v74, v69, v14 row_newbcast:3 row_mask:0xf bank_mask:0xf
    v_and_b32_dpp v75, v69, v15 row_newbcast:3 row_mask:0xf bank_mask:0xf
    s_waitcnt vmcnt(3)
    ds_read_b128 v[208:211], v228 offset:12288
    s_waitcnt lgkmcnt(1)
    v_mfma_f32_16x16x32_bf16 v[80:83], v[76:79], v[204:207], v[80:83]
    v_and_b32_dpp v76, v69, v12 row_newbcast:7 row_mask:0xf bank_mask:0xf
    v_and_b32_dpp v77, v69, v13 row_newbcast:7 row_mask:0xf bank_mask:0xf
    v_and_b32_dpp v78, v69, v14 row_newbcast:7 row_mask:0xf bank_mask:0xf
    v_and_b32_dpp v79, v69, v15 row_newbcast:7 row_mask:0xf bank_mask:0xf
    s_waitcnt vmcnt(2)
    ds_read_b128 v[212:215], v228 offset:13312
    s_waitcnt lgkmcnt(1)
    v_mfma_f32_16x16x32_bf16 v[80:83], v[72:75], v[208:211], v[80:83]
    v_and_b32_dpp v72, v69, v12 row_newbcast:11 row_mask:0xf bank_mask:0xf
    v_and_b32_dpp v73, v69, v13 row_newbcast:11 row_mask:0xf bank_mask:0xf
    v_and_b32_dpp v74, v69, v14 row_newbcast:11 row_mask:0xf bank_mask:0xf
    v_and_b32_dpp v75, v69, v15 row_newbcast:11 row_mask:0xf bank_mask:0xf
    s_waitcnt vmcnt(1)
    ds_read_b128 v[216:219], v228 offset:14336
    s_waitcnt lgkmcnt(1)
    v_mfma_f32_16x16x32_bf16 v[80:83], v[76:79], v[212:215], v[80:83]
    v_and_b32_dpp v76, v69, v12 row_newbcast:15 row_mask:0xf bank_mask:0xf
    v_and_b32_dpp v77, v69, v13 row_newbcast:15 row_mask:0xf bank_mask:0xf
    v_and_b32_dpp v78, v69, v14 row_newbcast:15 row_mask:0xf bank_mask:0xf
    v_and_b32_dpp v79, v69, v15 row_newbcast:15 row_mask:0xf bank_mask:0xf
    s_waitcnt vmcnt(0)
    ds_read_b128 v[220:223], v228 offset:15360
    s_waitcnt lgkmcnt(1)
    v_mfma_f32_16x16x32_bf16 v[80:83], v[72:75], v[216:219], v[80:83]
    s_waitcnt lgkmcnt(0)
    v_mfma_f32_16x16x32_bf16 v[80:83], v[76:79], v[220:223], v[80:83]
    v_lshlrev_b32 v4, 5, v11
    v_lshl_add_u32 v4, v10, 4, v4
    s_lshl_b32 s62, s3, 9
    v_add_u32 v4, s62, v4
    s_mov_b32 exec_hi, 0
    s_nop 2
    ds_write_b128 v4, v[80:83] offset:512
    s_mov_b32 exec_hi, -1
    s_waitcnt lgkmcnt(0)
    s_barrier
    s_cmp_eq_u32 s26, 0
    s_cbranch_scc1 L_nonF
    s_lshl_b32 s14, s27, 5
    s_add_u32 s40, s28, s14
    s_addc_u32 s41, s29, 0
    s_mov_b32 s42, 1406304
    s_mov_b32 s43, 0x20000
    s_add_u32 s44, s30, s14
    s_addc_u32 s45, s31, 0
    s_mov_b32 s46, 1406304
    s_mov_b32 s47, 0x20000
    s_lshl_b32 s14, s27, 14
    s_add_u32 s56, s32, s14
    s_addc_u32 s57, s33, 0
    s_mov_b32 s58, 16384
    s_mov_b32 s59, 0x20000
    v_lshrrev_b32 v5, 3, v1
    v_and_b32 v5, 3, v5
    v_lshlrev_b32 v5, 3, v5
    v_lshrrev_b32 v6, 5, v1
    v_lshl_add_u32 v5, v6, 2, v5
    v_lshrrev_b32 v6, 1, v1
    v_and_b32 v6, 3, v6
    v_add_u32 v5, v5, v6
    v_mul_u32_u24 v5, 2752, v5
    v_and_b32 v6, 1, v1
    v_lshl_add_u32 v5, v6, 4, v5
    v_lshlrev_b32 v4, 4, v1
    s_sub_u32 s13, s3, 4
    s_mul_i32 s14, s13, 352256
    s_lshl_b32 s15, s13, 12
    s_lshl_b32 s62, s13, 12
    s_mul_i32 s63, s13, 4224
    s_waitcnt vmcnt(0)
    s_mov_b32 s64, s62
    s_mov_b32 s65, s63
    s_bitcmp1_b32 s9, 0
    s_cbranch_scc1 Llt_24
    s_cmp_eq_u32 s3, 7
    s_cbranch_scc1 Llt_24
    s_mul_i32 s62, s10, 3
    s_add_u32 s62, s62, s3
    s_sub_u32 s62, s62, 4
    s_cmp_ge_u32 s62, 48
    s_cselect_b32 s63, 48, 0
    s_cselect_b32 s52, s30, s28
    s_cselect_b32 s53, s31, s29
    s_mov_b32 s54, 1409024
    s_mov_b32 s55, 0x20000
    s_sub_u32 s62, s62, s63
    s_lshl_b32 s62, s62, 6
    v_add_u32 v7, s62, v1
    v_mul_u32_u24 v8, 10923, v7
    v_lshrrev_b32 v8, 16, v8
    v_mul_u32_u24 v9, 6, v8
    v_sub_u32 v7, v7, v9
    v_lshlrev_b32 v7, 7, v7
    s_lshr_b32 s62, s9, 1
    s_cmp_eq_u32 s62, 3
    s_mov_b32 s63, 700
    s_cselect_b32 s63, 636, s63
    s_mul_i32 s62, s62, 704
    v_min_u32 v7, s63, v7
    v_mul_u32_u24 v8, 2752, v8
    v_add_u32 v7, v7, v8
    v_add_u32 v225, s62, v7
    buffer_load_dword v225, v225, s[52:55], 0 offen
Llt_24:
    s_mov_b32 s62, s64
    s_mov_b32 s63, s65
    s_barrier
    s_add_u32 m0, s63, 57344
    s_nop 0
    buffer_load_dwordx4 v4, s[56:59], s62 offen offset:0 nt lds
    s_add_u32 m0, s63, 57376
    s_nop 0
    buffer_load_dwordx4 v4, s[56:59], s62 offen offset:1024 nt lds
    s_add_u32 m0, s63, 57408
    s_nop 0
    buffer_load_dwordx4 v4, s[56:59], s62 offen offset:2048 nt lds
    s_add_u32 m0, s63, 57440
    s_nop 0
    buffer_load_dwordx4 v4, s[56:59], s62 offen offset:3072 nt lds
    s_barrier
    s_add_u32 m0, s15, 24576
    s_nop 0
    buffer_load_dwordx4 v5, s[40:43], s14 offen lds
    s_add_u32 m0, s15, 40960
    s_nop 0
    buffer_load_dwordx4 v5, s[44:47], s14 offen lds
    s_add_u32 s14, s14, 88064
    s_add_u32 m0, s15, 25600
    s_nop 0
    buffer_load_dwordx4 v5, s[40:43], s14 offen lds
    s_add_u32 m0, s15, 41984
    s_nop 0
    buffer_load_dwordx4 v5, s[44:47], s14 offen lds
    s_add_u32 s14, s14, 88064
    s_add_u32 m0, s15, 26624
    s_nop 0
    buffer_load_dwordx4 v5, s[40:43], s14 offen lds
    s_add_u32 m0, s15, 43008
    s_nop 0
    buffer_load_dwordx4 v5, s[44:47], s14 offen lds
    s_add_u32 s14, s14, 88064
    s_add_u32 m0, s15, 27648
    s_nop 0
    buffer_load_dwordx4 v5, s[40:43], s14 offen lds
    s_add_u32 m0, s15, 44032
    s_nop 0
    buffer_load_dwordx4 v5, s[44:47], s14 offen lds
    v_lshl_add_u32 v5, v1, 3, s15
    v_lshlrev_b32 v6, 4, v10
    s_lshl_b32 s63, s13, 7
    v_add_u32 v6, s63, v6
    s_waitcnt vmcnt(0)
    ds_read_b64_tr_b16 v[32:33], v5 offset:24576
    ds_read_b64_tr_b16 v[48:49], v5 offset:40960
    ds_read_b64_tr_b16 v[34:35], v5 offset:25088
    ds_read_b64_tr_b16 v[50:51], v5 offset:41472
    ds_read_b64_tr_b16 v[36:37], v5 offset:25600
    ds_read_b64_tr_b16 v[52:53], v5 offset:41984
    ds_read_b64_tr_b16 v[38:39], v5 offset:26112
    ds_read_b64_tr_b16 v[54:55], v5 offset:42496
    ds_read_b64_tr_b16 v[40:41], v5 offset:26624
    ds_read_b64_tr_b16 v[56:57], v5 offset:43008
    ds_read_b64_tr_b16 v[42:43], v5 offset:27136
    ds_read_b64_tr_b16 v[58:59], v5 offset:43520
    ds_read_b64_tr_b16 v[44:45], v5 offset:27648
    ds_read_b64_tr_b16 v[60:61], v5 offset:44032
    ds_read_b64_tr_b16 v[46:47], v5 offset:28160
    ds_read_b64_tr_b16 v[62:63], v5 offset:44544
    v_mov_b32 v72, s78
    v_mov_b32 v73, s78
    v_mov_b32 v74, s78
    v_mov_b32 v75, s78
    s_waitcnt lgkmcnt(0)
    s_nop 0
    v_mfma_f32_16x16x32_bf16 v[64:67], v[32:35], v[72:75], 0
    v_mfma_f32_16x16x32_bf16 v[68:71], v[48:51], v[72:75], 0
    v_mfma_f32_16x16x32_bf16 v[64:67], v[36:39], v[72:75], v[64:67]
    v_mfma_f32_16x16x32_bf16 v[68:71], v[52:55], v[72:75], v[68:71]
    v_mfma_f32_16x16x32_bf16 v[64:67], v[40:43], v[72:75], v[64:67]
    v_mfma_f32_16x16x32_bf16 v[68:71], v[56:59], v[72:75], v[68:71]
    v_mfma_f32_16x16x32_bf16 v[64:67], v[44:47], v[72:75], v[64:67]
    v_mfma_f32_16x16x32_bf16 v[68:71], v[60:63], v[72:75], v[68:71]
    s_mov_b32 s14, 0x00010001
    s_mov_b32 s15, 0x00010001
    s_mov_b64 exec, s[14:15]
    s_nop 3
    ds_write_b128 v6, v[64:67] offset:6784
    ds_write_b128 v6, v[68:71] offset:6848
    s_mov_b64 exec, -1
    s_waitcnt vmcnt(0) lgkmcnt(0)
    s_barrier
    s_branch L_done
L_nonF:
    s_waitcnt vmcnt(0)
    s_bitcmp1_b32 s9, 0
    s_cbranch_scc1 Llt_25
    s_cmp_eq_u32 s3, 7
    s_cbranch_scc1 Llt_25
    s_mul_i32 s62, s10, 3
    s_add_u32 s62, s62, s3
    s_sub_u32 s62, s62, 4
    s_cmp_ge_u32 s62, 48
    s_cselect_b32 s63, 48, 0
    s_cselect_b32 s40, s30, s28
    s_cselect_b32 s41, s31, s29
    s_mov_b32 s42, 1409024
    s_mov_b32 s43, 0x20000
    s_sub_u32 s62, s62, s63
    s_lshl_b32 s62, s62, 6
    v_add_u32 v7, s62, v1
    v_mul_u32_u24 v8, 10923, v7
    v_lshrrev_b32 v8, 16, v8
    v_mul_u32_u24 v9, 6, v8
    v_sub_u32 v7, v7, v9
    v_lshlrev_b32 v7, 7, v7
    s_lshr_b32 s62, s9, 1
    s_cmp_eq_u32 s62, 3
    s_mov_b32 s63, 700
    s_cselect_b32 s63, 636, s63
    s_mul_i32 s62, s62, 704
    v_min_u32 v7, s63, v7
    v_mul_u32_u24 v8, 2752, v8
    v_add_u32 v7, v7, v8
    v_add_u32 v225, s62, v7
    buffer_load_dword v225, v225, s[40:43], 0 offen
Llt_25:
    s_barrier
    s_cmp_lg_u32 s3, 4
    s_cbranch_scc1 L_done
    s_cmp_ge_u32 s36, 128
    s_cbranch_scc1 L_done
    s_lshr_b32 s12, s36, 2
    s_and_b32 s13, s36, 3
    s_lshl_b32 s13, s13, 6
    v_lshrrev_b32 v4, 2, v1
    v_and_b32 v5, 3, v1
    v_lshlrev_b32 v5, 4, v5
    v_lshl_add_u32 v6, v4, 8, v5
    s_lshl_b32 s14, s12, 13
    s_add_u32 s14, s14, s13
    s_add_u32 s14, s14, 131072
    s_add_u32 s15, s14, 4096
    v_lshl_add_u32 v7, v4, 13, v5
    s_lshl_b32 s63, s36, 6
    s_add_u32 s63, s63, 65536
    v_lshlrev_b32 v224, 16, v224
    v_mov_b32 v17, s8
    v_mov_b32 v19, s8
    v_and_b32 v56, s61, v232
    v_and_b32 v57, s61, v233
    v_and_b32 v58, s61, v234
    v_and_b32 v59, s61, v235
    s_mov_b32 s11, 40000
Ylp_26:
    s_nop 1
    buffer_load_dwordx4 v[20:23], v6, s[48:51], s14 offen sc1
    buffer_load_dwordx4 v[24:27], v6, s[48:51], s15 offen sc1
    s_waitcnt vmcnt(1)
    v_xor_b32 v20, v20, v56
    v_xor_b32 v21, v21, v57
    v_xor_b32 v22, v22, v58
    v_xor_b32 v23, v23, v59
    v_or3_b32 v28, v20, v21, v22
    v_or_b32 v28, v28, v23
    s_waitcnt vmcnt(0)
    v_xor_b32 v24, v24, v56
    v_xor_b32 v25, v25, v57
    v_xor_b32 v26, v26, v58
    v_xor_b32 v27, v27, v59
    v_or3_b32 v28, v28, v24, v25
    v_or3_b32 v28, v28, v26, v27
    v_and_b32 v28, 0xff, v28
    v_cmp_eq_u32 vcc, 0, v28
    s_nop 0
    s_cmp_eq_u64 vcc, -1
    s_cbranch_scc1 Ydn_27
    s_sub_u32 s11, s11, 1
    s_cmp_lg_u32 s11, 0
    s_cbranch_scc1 Ylp_26
Ydn_27:
    s_nop 1
    v_pk_add_f32 v[20:21], v[20:21], v[24:25]
    v_pk_add_f32 v[22:23], v[22:23], v[26:27]
    s_nop 1
    v_permlane32_swap_b32 v20, v22
    v_permlane32_swap_b32 v21, v23
    v_add_f32 v20, v20, v22
    v_add_f32 v21, v21, v23
    s_nop 1
    v_permlane16_swap_b32 v20, v21
    v_add_f32 v20, v20, v21
    s_nop 1
    v_add_f32_dpp v20, v20, v20 row_ror:4 row_mask:0xf bank_mask:0xf
    s_nop 1
    v_add_f32_dpp v20, v20, v20 row_ror:8 row_mask:0xf bank_mask:0xf
    v_cvt_pk_bf16_f32 v20, v20, v20
    v_and_b32 v20, 0xffff0000, v20
    v_add_f32 v20, v20, v224
    v_mov_b32 v21, v20
    s_nop 1
    v_permlane16_swap_b32 v20, v21
    v_cvt_pk_bf16_f32 v16, v20, v21
    v_mov_b32 v18, v16
    v_mov_b32 v29, v16
    s_nop 0
    v_permlane32_swap_b32 v16, v18
    s_mov_b32 exec_hi, 0
    buffer_store_dwordx4 v[16:19], v7, s[48:51], s63 offen sc1
    s_mov_b64 exec, -1
    s_mul_i32 s14, s36, 5632
    s_add_u32 s14, s14, 1114112
    v_lshlrev_b32 v6, 4, v1
    s_add_u32 s15, s14, 1024
    s_add_u32 s64, s14, 2048
    s_add_u32 s65, s14, 3072
    s_add_u32 s66, s14, 4096
    s_add_u32 s67, s14, 5120
    v_and_b32 v52, s61, v232
    v_and_b32 v53, s61, v233
    v_and_b32 v54, s61, v234
    v_and_b32 v55, s61, v235
    s_mov_b32 s16, s34
    s_mov_b32 s17, s35
    s_mov_b32 s18, 4096
    s_mov_b32 s19, 0x20000
    v_and_b32 v56, s61, v232
    v_mov_b32 v52, 0
    v_and_b32 v57, s61, v233
    v_mov_b32 v53, 0
    v_and_b32 v58, s61, v234
    v_mov_b32 v54, 0
    v_and_b32 v59, s61, v235
    v_mov_b32 v55, 0
    v_lshlrev_b32 v23, 16, v29
    v_and_b32 v24, 0xffff0000, v29
    v_lshlrev_b32 v5, 6, v5
    v_lshrrev_b32 v8, 5, v1
    v_lshl_add_u32 v5, v8, 2, v5
    s_lshl_b32 s62, s36, 3
    s_mov_b32 s68, 15
    s_mov_b32 s69, 15
    s_mov_b32 s11, 40000
Dlp_28:
    s_nop 1
    buffer_load_dwordx4 v[32:35], v6, s[48:51], s14 offen sc1
    buffer_load_dwordx4 v[36:39], v6, s[48:51], s15 offen sc1
    buffer_load_dwordx4 v[40:43], v6, s[48:51], s64 offen sc1
    buffer_load_dwordx4 v[44:47], v6, s[48:51], s65 offen sc1
    buffer_load_dwordx4 v[48:51], v6, s[48:51], s66 offen sc1
    s_mov_b64 exec, 0xffffff
    buffer_load_dwordx4 v[52:55], v6, s[48:51], s67 offen sc1
    s_mov_b64 exec, -1
    s_waitcnt vmcnt(5)
    v_xor_b32 v32, v32, v56
    v_xor_b32 v33, v33, v57
    v_xor_b32 v34, v34, v58
    v_xor_b32 v35, v35, v59
    v_or3_b32 v28, v32, v33, v34
    v_or_b32 v28, v28, v35
    s_waitcnt vmcnt(4)
    v_xor_b32 v36, v36, v56
    v_xor_b32 v37, v37, v57
    v_xor_b32 v38, v38, v58
    v_xor_b32 v39, v39, v59
    v_or3_b32 v28, v28, v36, v37
    v_or3_b32 v28, v28, v38, v39
    s_waitcnt vmcnt(3)
    v_xor_b32 v40, v40, v56
    v_xor_b32 v41, v41, v57
    v_xor_b32 v42, v42, v58
    v_xor_b32 v43, v43, v59
    v_or3_b32 v28, v28, v40, v41
    v_or3_b32 v28, v28, v42, v43
    s_waitcnt vmcnt(2)
    v_xor_b32 v44, v44, v56
    v_xor_b32 v45, v45, v57
    v_xor_b32 v46, v46, v58
    v_xor_b32 v47, v47, v59
    v_or3_b32 v28, v28, v44, v45
    v_or3_b32 v28, v28, v46, v47
    s_waitcnt vmcnt(1)
    v_xor_b32 v48, v48, v56
    v_xor_b32 v49, v49, v57
    v_xor_b32 v50, v50, v58
    v_xor_b32 v51, v51, v59
    v_or3_b32 v28, v28, v48, v49
    v_or3_b32 v28, v28, v50, v51
    s_waitcnt vmcnt(0)
    s_mov_b64 exec, 0xffffff
    v_xor_b32 v52, v52, v56
    v_xor_b32 v53, v53, v57
    v_xor_b32 v54, v54, v58
    v_xor_b32 v55, v55, v59
    s_mov_b64 exec, -1
    v_or3_b32 v28, v28, v52, v53
    v_or3_b32 v28, v28, v54, v55
    v_and_b32 v28, 0xff, v28
    v_cmp_eq_u32 vcc, 0, v28
    s_nop 0
    s_cmp_eq_u64 vcc, -1
    s_cbranch_scc1 Ddn_29
    s_sub_u32 s11, s11, 1
    s_cmp_lg_u32 s11, 0
    s_cbranch_scc1 Dlp_28
Ddn_29:
    s_nop 1
    v_pk_add_f32 v[32:33], v[32:33], v[36:37]
    v_pk_add_f32 v[40:41], v[40:41], v[44:45]
    v_pk_add_f32 v[48:49], v[48:49], v[52:53]
    v_pk_add_f32 v[34:35], v[34:35], v[38:39]
    v_pk_add_f32 v[42:43], v[42:43], v[46:47]
    v_pk_add_f32 v[50:51], v[50:51], v[54:55]
    v_pk_add_f32 v[32:33], v[32:33], v[40:41]
    v_pk_add_f32 v[34:35], v[34:35], v[42:43]
    v_pk_add_f32 v[32:33], v[32:33], v[48:49]
    v_pk_add_f32 v[34:35], v[34:35], v[50:51]
    s_nop 1
    v_permlane32_swap_b32 v32, v34
    v_permlane32_swap_b32 v33, v35
    v_add_f32 v32, v32, v34
    v_add_f32 v33, v33, v35
    s_nop 1
    v_permlane16_swap_b32 v32, v33
    v_add_f32 v32, v32, v33
    s_nop 1
    v_add_f32_dpp v32, v32, v32 row_ror:4 row_mask:0xf bank_mask:0xf
    s_nop 1
    v_add_f32_dpp v32, v32, v32 row_ror:8 row_mask:0xf bank_mask:0xf
    v_cvt_pk_bf16_f32 v32, v32, v32
    v_and_b32 v32, 0xffff0000, v32
    v_mov_b32 v33, v32
    s_nop 1
    v_permlane16_swap_b32 v32, v33
    v_add_f32 v32, v32, v23
    v_add_f32 v33, v33, v24
    v_cvt_pk_bf16_f32 v20, v32, v33
    s_mov_b64 exec, s[68:69]
    buffer_store_dword v20, v5, s[16:19], s62 offen
    s_mov_b64 exec, -1
    s_cmp_lg_u32 s36, 0
    s_cbranch_scc1 Lfin_noep
    v_mov_b32 v16, s8
    v_mov_b32 v17, 0
    s_mov_b64 exec, 1
    buffer_store_dword v16, v17, s[48:51], 0 offen sc1
    s_mov_b64 exec, -1
Lfin_noep:
L_done:
    s_waitcnt vmcnt(0)
L_end:
    s_endpgm
.section .rodata,"a"
.p2align 6
.amdhsa_kernel sequential_preLN__sliding_block_cached__glu_gated_bilinear__decode_kernel
  .amdhsa_next_free_vgpr 256
  .amdhsa_next_free_sgpr 102
  .amdhsa_accum_offset 256
  .amdhsa_group_segment_fixed_size 0
  .amdhsa_kernarg_size 96
  .amdhsa_user_sgpr_count 2
  .amdhsa_user_sgpr_kernarg_segment_ptr 1
  .amdhsa_system_sgpr_workgroup_id_x 1
  .amdhsa_float_denorm_mode_32 3
  .amdhsa_float_denorm_mode_16_64 3
.end_amdhsa_kernel
```
